```python
import torch

def _softmax(x, axis=-1):
    return torch.softmax(x, dim=axis)
def _gelu(x):
    return torch.nn.functional.gelu(x, approximate="tanh")
def _silu(x):
    return torch.nn.functional.silu(x)
def _sigmoid(x):
    return torch.sigmoid(x)
def _layernorm(x, axis=-1, eps=1e-5):
    m = x.mean(dim=axis, keepdim=True)
    v = x.var(dim=axis, keepdim=True, unbiased=False)
    return (x - m) / torch.sqrt(v + eps)
def _scatter_add(tgt, idx, src, axis=0):
    return tgt.clone().index_add_(axis, idx, src)
def _segment_sum(src, seg, n):
    out = torch.zeros((n,) + src.shape[1:], dtype=src.dtype)
    return out.index_add_(0, seg, src)
def _pad(x, pw):
    flat = tuple(v for pair in reversed(pw) for v in pair)
    return torch.nn.functional.pad(x, flat)

kernel_name = 'standalone__detection_seg_fpn_lateral__vision'

def setup_inputs():

    _w = (lambda a: (lambda t: t.to(torch.bfloat16) if t.is_floating_point() else t)(torch.as_tensor(a)))
    H = W = (384 // 2) * 2
    C = 384
    k = 1
    return {
        "c_fine": _w((lambda *s: torch.randn(*s, dtype=torch.bfloat16) * 0.05)(1, H, W, C)),
        "p_coarse": _w((lambda *s: torch.randn(*s, dtype=torch.bfloat16) * 0.05)(1, H // 2, W // 2, C)),
        "w_lat": _w((lambda *s: torch.randn(*s, dtype=torch.bfloat16) * 0.05)(C, C)),
        "w_out": _w((lambda *s: torch.randn(*s, dtype=torch.bfloat16) * 0.05)(k, k, C, C)),
    }

def reference(c_fine, p_coarse, w_lat, w_out):
    B, H, W, C = c_fine.shape
    k = 1
    lat = torch.einsum("bhwc,cd->bhwd", c_fine, w_lat)
    up = (lambda x, n, axis: torch.repeat_interleave(x, n, dim=axis))((lambda x, n, axis: torch.repeat_interleave(x, n, dim=axis))(p_coarse, 2, axis=1), 2, axis=2)
    m = lat + up
    pad = k // 2
    mp = _pad(m, ((0, 0), (pad, pad), (pad, pad), (0, 0)))
    o = None
    for di in range(k):
        for dj in range(k):
            t = torch.einsum("bhwc,cd->bhwd", mp[:, di:di + H, dj:dj + W, :], w_out[di, dj])
            o = t if o is None else o + t
    return o
```

```asm
; @launch grid=(256,1,1) block=(256,1,1) lds=163840
.amdgcn_target "amdgcn-amd-amdhsa--gfx950"
.text
.globl standalone__detection_seg_fpn_lateral__vision_kernel
.p2align 8
.type standalone__detection_seg_fpn_lateral__vision_kernel,@function
standalone__detection_seg_fpn_lateral__vision_kernel:
    s_cmp_ge_u32 s2, 256
    s_cbranch_scc1 L_end
    s_load_dwordx8 s[72:79], s[0:1], 0
    s_load_dwordx4 s[80:83], s[0:1], 32
    s_load_dwordx2 s[84:85], s[0:1], 48
    v_and_b32 v84, 63, v0
    v_lshrrev_b32 v85, 6, v0
    v_and_b32 v86, 15, v0
    v_bfe_u32 v87, v0, 4, 2
    v_readfirstlane_b32 s3, v85
    s_bfe_u32 s40, s2, 0x50003
    s_lshr_b32 s88, s2, 1
    s_and_b32 s39, s2, 1
    s_lshl_b32 s39, s39, 7
    s_add_u32 s88, s88, s39
    s_getpc_b64 s[68:69]
    s_lshl_b32 s38, s40, 8
    v_add_u32 v116, s38, v0
    v_and_b32 v116, 0x7ff, v116
    v_lshlrev_b32 v116, 4, v116
    v_mov_b32 v117, s69
    v_add_co_u32 v116, vcc, s68, v116
    v_addc_co_u32 v117, vcc, 0, v117, vcc
    global_load_dwordx4 v[28:31], v[116:117], off
    v_lshlrev_b32 v114, 4, v0
    s_cmp_lt_u32 s88, 128
    s_cselect_b64 vcc, -1, 0
    s_cselect_b32 s89, 1, 0
    s_cmp_lt_u32 s88, 72
    s_cselect_b32 s89, 2, s89
    s_mul_i32 s36, s3, 6144
    s_mov_b32 s93, s40
    s_and_b32 s65, s2, 7
    s_lshl_b32 s65, s65, 5
    s_add_u32 s65, s65, s40
    s_lshr_b32 s38, s3, 1
    s_mul_i32 s38, s38, 255
    s_add_u32 s38, s38, s65
    s_mul_i32 s37, s38, 12288
    v_mul_u32_u24 v90, 384, v85
    v_add_u32 v90, v90, v84
    v_add_u32 v88, 0, v90
    v_mul_u32_u24 v89, 683, v88
    v_lshrrev_b32 v89, 16, v89
    v_xor_b32 v89, v88, v89
    v_lshlrev_b32 v89, 4, v89
    v_subrev_u32 v0, 0, v89
    v_add_u32 v88, 64, v90
    v_mul_u32_u24 v89, 683, v88
    v_lshrrev_b32 v89, 16, v89
    v_xor_b32 v89, v88, v89
    v_lshlrev_b32 v89, 4, v89
    v_subrev_u32 v1, 1024, v89
    v_add_u32 v88, 128, v90
    v_mul_u32_u24 v89, 683, v88
    v_lshrrev_b32 v89, 16, v89
    v_xor_b32 v89, v88, v89
    v_lshlrev_b32 v89, 4, v89
    v_subrev_u32 v2, 2048, v89
    v_add_u32 v88, 192, v90
    v_mul_u32_u24 v89, 683, v88
    v_lshrrev_b32 v89, 16, v89
    v_xor_b32 v89, v88, v89
    v_lshlrev_b32 v89, 4, v89
    v_subrev_u32 v3, 0, v89
    v_add_u32 v88, 256, v90
    v_mul_u32_u24 v89, 683, v88
    v_lshrrev_b32 v89, 16, v89
    v_xor_b32 v89, v88, v89
    v_lshlrev_b32 v89, 4, v89
    v_subrev_u32 v4, 1024, v89
    v_add_u32 v88, 320, v90
    v_mul_u32_u24 v89, 683, v88
    v_lshrrev_b32 v89, 16, v89
    v_xor_b32 v89, v88, v89
    v_lshlrev_b32 v89, 4, v89
    v_subrev_u32 v5, 2048, v89
    s_waitcnt lgkmcnt(0)
    s_mov_b32 s24, s78
    s_mov_b32 s25, s79
    s_mov_b32 s26, 294912
    s_mov_b32 s27, 0x00020000
    s_mov_b32 s12, s74
    s_mov_b32 s13, s75
    s_mov_b32 s14, 28311552
    s_mov_b32 s15, 0x00020000
    s_cbranch_vccnz L_skip1
    s_mul_i32 s40, s40, 12288
    buffer_load_dwordx4 v[28:31], v114, s[24:27], s40 offen
    s_add_u32 s40, s40, 4096
    buffer_load_dwordx4 v[28:31], v114, s[24:27], s40 offen
    s_add_u32 s40, s40, 4096
    buffer_load_dwordx4 v[28:31], v114, s[24:27], s40 offen
L_skip1:
    s_cmp_ge_u32 s88, 72
    s_cbranch_scc1 L_skip2
    s_mov_b32 s28, s76
    s_mov_b32 s29, s77
    s_mov_b32 s30, 294912
    s_mov_b32 s31, 0x00020000
    s_lshr_b32 s39, s88, 2
    s_mul_i32 s38, s39, 10923
    s_lshr_b32 s38, s38, 16
    s_mul_i32 s40, s38, 6
    s_sub_u32 s39, s39, s40
    s_and_b32 s40, s88, 3
    s_mul_i32 s40, s40, 3
    s_add_u32 s38, s38, s40
    v_lshrrev_b32 v88, 3, v84
    v_mul_u32_u24 v88, 768, v88
    v_and_b32 v89, 7, v84
    v_lshl_add_u32 v88, v89, 4, v88
    s_lshl_b32 s70, s39, 7
    s_mul_i32 s40, s3, 73728
    s_add_u32 s70, s70, s40
    s_lshl_b32 s71, s36, 1
    s_add_u32 m0, s71, 0
    s_nop 0
    buffer_load_dwordx4 v88, s[24:27], s70 offen lds
    s_add_u32 s70, s70, 6144
    s_add_u32 m0, s71, 1024
    s_nop 0
    buffer_load_dwordx4 v88, s[24:27], s70 offen lds
    s_add_u32 s70, s70, 6144
    s_add_u32 m0, s71, 2048
    s_nop 0
    buffer_load_dwordx4 v88, s[24:27], s70 offen lds
    s_add_u32 s70, s70, 6144
    s_add_u32 m0, s71, 3072
    s_nop 0
    buffer_load_dwordx4 v88, s[24:27], s70 offen lds
    s_add_u32 s70, s70, 6144
    s_add_u32 m0, s71, 4096
    s_nop 0
    buffer_load_dwordx4 v88, s[24:27], s70 offen lds
    s_add_u32 s70, s70, 6144
    s_add_u32 m0, s71, 5120
    s_nop 0
    buffer_load_dwordx4 v88, s[24:27], s70 offen lds
    s_add_u32 s70, s70, 6144
    s_add_u32 m0, s71, 6144
    s_nop 0
    buffer_load_dwordx4 v88, s[24:27], s70 offen lds
    s_add_u32 s70, s70, 6144
    s_add_u32 m0, s71, 7168
    s_nop 0
    buffer_load_dwordx4 v88, s[24:27], s70 offen lds
    s_add_u32 s70, s70, 6144
    s_add_u32 m0, s71, 8192
    s_nop 0
    buffer_load_dwordx4 v88, s[24:27], s70 offen lds
    s_add_u32 s70, s70, 6144
    s_add_u32 m0, s71, 9216
    s_nop 0
    buffer_load_dwordx4 v88, s[24:27], s70 offen lds
    s_add_u32 s70, s70, 6144
    s_add_u32 m0, s71, 10240
    s_nop 0
    buffer_load_dwordx4 v88, s[24:27], s70 offen lds
    s_add_u32 s70, s70, 6144
    s_add_u32 m0, s71, 11264
    s_nop 0
    buffer_load_dwordx4 v88, s[24:27], s70 offen lds
    s_lshl_b32 s39, s39, 1
    s_lshr_b32 s40, s3, 1
    s_add_u32 s39, s39, s40
    s_mul_i32 s86, s39, 21846
    s_lshr_b32 s86, s86, 16
    s_mul_i32 s40, s86, 3
    s_sub_u32 s39, s39, s40
    s_and_b32 s40, s86, 1
    s_sub_u32 s39, s39, s40
    s_cmp_eq_u32 s39, -1
    s_cselect_b32 s39, 2, s39
    s_mul_i32 s87, s86, 72
    s_mul_i32 s40, s38, 6
    s_add_u32 s87, s87, s40
    s_lshl_b32 s40, s39, 1
    s_add_u32 s87, s87, s40
    s_and_b32 s40, s3, 1
    s_add_u32 s87, s87, s40
    s_lshl_b32 s87, s87, 10
    s_mul_i32 s38, s38, 24576
    s_add_u32 m0, s36, 98304
    s_nop 0
    buffer_load_dwordx4 v0, s[28:31], s38 offen offset:0 lds
    buffer_load_dwordx4 v1, s[28:31], s38 offen offset:1024 lds
    buffer_load_dwordx4 v2, s[28:31], s38 offen offset:2048 lds
    s_add_u32 m0, s36, 101376
    s_nop 0
    buffer_load_dwordx4 v3, s[28:31], s38 offen offset:0 lds
    buffer_load_dwordx4 v4, s[28:31], s38 offen offset:1024 lds
    buffer_load_dwordx4 v5, s[28:31], s38 offen offset:2048 lds
L_skip2:
    s_cmp_lt_u32 s88, 72
    s_cbranch_scc1 L_skip17
    s_add_u32 s70, s37, 0
    s_add_u32 m0, s36, 49152
    s_nop 0
    buffer_load_dwordx4 v0, s[12:15], s70 offen offset:0 nt lds
    buffer_load_dwordx4 v1, s[12:15], s70 offen offset:1024 nt lds
    buffer_load_dwordx4 v2, s[12:15], s70 offen offset:2048 nt lds
    s_add_u32 s70, s37, 0
    s_add_u32 m0, s36, 52224
    s_nop 0
    buffer_load_dwordx4 v3, s[12:15], s70 offen offset:0 nt lds
    buffer_load_dwordx4 v4, s[12:15], s70 offen offset:1024 nt lds
    buffer_load_dwordx4 v5, s[12:15], s70 offen offset:2048 nt lds
L_skip17:
    v_mul_u32_u24 v90, 192, v85
    v_add_u32 v88, 0, v84
    v_mul_u32_u24 v89, 5462, v88
    v_lshrrev_b32 v89, 16, v89
    v_lshlrev_b32 v88, 4, v88
    v_mul_u32_u24 v89, 576, v89
    v_add3_u32 v88, v88, v89, v90
    v_subrev_u32 v108, 0, v88
    v_add_u32 v88, 64, v84
    v_mul_u32_u24 v89, 5462, v88
    v_lshrrev_b32 v89, 16, v89
    v_lshlrev_b32 v88, 4, v88
    v_mul_u32_u24 v89, 576, v89
    v_add3_u32 v88, v88, v89, v90
    v_subrev_u32 v109, 1024, v88
    v_add_u32 v88, 128, v84
    v_mul_u32_u24 v89, 5462, v88
    v_lshrrev_b32 v89, 16, v89
    v_lshlrev_b32 v88, 4, v88
    v_mul_u32_u24 v89, 576, v89
    v_add3_u32 v88, v88, v89, v90
    v_subrev_u32 v110, 2048, v88
    v_add_u32 v88, 192, v84
    v_mul_u32_u24 v89, 5462, v88
    v_lshrrev_b32 v89, 16, v89
    v_lshlrev_b32 v88, 4, v88
    v_mul_u32_u24 v89, 576, v89
    v_add3_u32 v88, v88, v89, v90
    v_subrev_u32 v111, 0, v88
    v_add_u32 v88, 256, v84
    v_mul_u32_u24 v89, 5462, v88
    v_lshrrev_b32 v89, 16, v89
    v_lshlrev_b32 v88, 4, v88
    v_mul_u32_u24 v89, 576, v89
    v_add3_u32 v88, v88, v89, v90
    v_subrev_u32 v112, 1024, v88
    v_add_u32 v88, 320, v84
    v_mul_u32_u24 v89, 5462, v88
    v_lshrrev_b32 v89, 16, v89
    v_lshlrev_b32 v88, 4, v88
    v_mul_u32_u24 v89, 576, v89
    v_add3_u32 v88, v88, v89, v90
    v_subrev_u32 v113, 2048, v88
    s_mov_b32 s8, s72
    s_mov_b32 s9, s73
    s_mov_b32 s10, 113246208
    s_mov_b32 s11, 0x00020000
    s_mov_b32 s20, s80
    s_mov_b32 s21, s81
    s_mov_b32 s22, 113246208
    s_mov_b32 s23, 0x00020000
    s_mov_b32 s32, s82
    s_mov_b32 s33, s83
    s_mov_b32 s34, 256
    s_mov_b32 s35, 0x00020000
    s_mov_b32 s16, s84
    s_mov_b32 s17, s85
    s_mov_b32 s18, 294912
    s_mov_b32 s19, 0x00020000
    s_mov_b32 s72, s12
    s_mov_b32 s73, s13
    s_mov_b32 s74, 28311552
    s_mov_b32 s75, 0x00020000
    s_and_b32 s38, s3, 1
    s_lshl_b32 s39, s38, 6
    v_lshrrev_b32 v88, 2, v86
    v_lshl_add_u32 v88, v87, 3, v88
    v_mul_u32_u24 v88, 192, v88
    v_and_b32 v89, 3, v86
    v_lshl_add_u32 v88, v89, 4, v88
    v_add_u32 v88, s36, v88
    s_and_b32 s38, s3, 1
    s_lshl_b32 s39, s38, 6
    v_add_u32 v92, s39, v88
    v_add_u32 v93, 64, v92
    s_xor_b32 s40, s38, 1
    s_lshl_b32 s40, s40, 7
    v_add_u32 v94, s40, v88
    v_add_u32 v95, 73728, v92
    v_add_u32 v96, 73728, v93
    v_add_u32 v97, 73728, v94
    v_and_b32 v88, 7, v86
    v_mul_u32_u24 v88, 1536, v88
    v_lshrrev_b32 v89, 3, v86
    v_lshl_add_u32 v88, v89, 6, v88
    v_lshl_add_u32 v88, v87, 4, v88
    v_add3_u32 v12, v88, v90, s39
    v_add_u32 v13, 12288, v12
    s_lshl_b32 s40, s38, 2
    v_add_u32 v88, s40, v87
    v_and_b32 v89, 7, v86
    v_xor_b32 v88, v88, v89
    v_lshlrev_b32 v88, 4, v88
    v_lshl_add_u32 v88, v86, 7, v88
    s_lshr_b32 s39, s3, 1
    s_lshl_b32 s40, s39, 11
    s_add_u32 s40, s40, 147456
    v_add_u32 v10, s40, v88
    v_lshrrev_b32 v88, 3, v84
    v_and_b32 v89, 7, v84
    v_xor_b32 v90, v88, v89
    v_lshlrev_b32 v90, 4, v90
    s_lshl_b32 s38, s38, 3
    v_add_u32 v88, s38, v88
    v_lshl_add_u32 v90, v88, 7, v90
    v_add_u32 v11, s40, v90
    v_mul_u32_u24 v88, 1536, v88
    v_lshl_add_u32 v88, v89, 4, v88
    s_mul_i32 s39, s39, 384
    s_add_u32 s39, s39, 128
    v_add_u32 v14, s39, v88
    v_lshrrev_b32 v90, 1, v86
    v_add_u32 v88, 0, v87
    v_xor_b32 v89, v88, v86
    v_lshlrev_b32 v89, 4, v89
    v_mul_u32_u24 v6, 1536, v86
    v_add_u32 v6, v6, v89
    v_xor_b32 v89, v88, v90
    v_lshlrev_b32 v89, 4, v89
    v_mul_u32_u24 v88, 768, v86
    v_add_u32 v88, v88, v89
    v_add_u32 v32, 49152, v88
    v_add_u32 v216, 98304, v88
    v_add_u32 v88, 4, v87
    v_xor_b32 v89, v88, v86
    v_lshlrev_b32 v89, 4, v89
    v_mul_u32_u24 v7, 1536, v86
    v_add_u32 v7, v7, v89
    v_xor_b32 v89, v88, v90
    v_lshlrev_b32 v89, 4, v89
    v_mul_u32_u24 v88, 768, v86
    v_add_u32 v88, v88, v89
    v_add_u32 v33, 49152, v88
    v_add_u32 v217, 98304, v88
    v_add_u32 v88, 8, v87
    v_xor_b32 v89, v88, v86
    v_lshlrev_b32 v89, 4, v89
    v_mul_u32_u24 v8, 1536, v86
    v_add_u32 v8, v8, v89
    v_xor_b32 v89, v88, v90
    v_lshlrev_b32 v89, 4, v89
    v_mul_u32_u24 v88, 768, v86
    v_add_u32 v88, v88, v89
    v_add_u32 v34, 49152, v88
    v_add_u32 v218, 98304, v88
    v_add_u32 v88, 12, v87
    v_xor_b32 v89, v88, v86
    v_lshlrev_b32 v89, 4, v89
    v_mul_u32_u24 v9, 1536, v86
    v_add_u32 v9, v9, v89
    v_xor_b32 v89, v88, v90
    v_lshlrev_b32 v89, 4, v89
    v_mul_u32_u24 v88, 768, v86
    v_add_u32 v88, v88, v89
    v_add_u32 v35, 49152, v88
    v_add_u32 v219, 98304, v88
    v_mul_u32_u24 v15, 73728, v85
    v_lshl_add_u32 v15, v84, 4, v15
    v_mov_b32 v221, 1
    v_mov_b32 v222, 0
    s_mul_i32 s38, s65, 1
    s_add_u32 s39, s38, 0
    s_mul_i32 s40, s39, 43691
    s_lshr_b32 s40, s40, 19
    s_mul_i32 s40, s40, 12
    s_add_u32 s40, s40, s39
    s_mul_i32 s41, s40, 24576
    s_add_u32 s42, s41, 294912
    s_add_u32 s39, s38, 256
    s_mul_i32 s40, s39, 43691
    s_lshr_b32 s40, s40, 19
    s_mul_i32 s40, s40, 12
    s_add_u32 s40, s40, s39
    s_mul_i32 s43, s40, 24576
    s_add_u32 s44, s43, 294912
    s_add_u32 s39, s38, 512
    s_mul_i32 s40, s39, 43691
    s_lshr_b32 s40, s40, 19
    s_mul_i32 s40, s40, 12
    s_sub_u32 s53, s39, s40
    s_add_u32 s40, s40, s39
    s_mul_i32 s45, s40, 24576
    s_add_u32 s46, s45, 294912
    s_mov_b32 s47, 0x80000000
    s_mov_b32 s48, s41
    s_mov_b32 s49, s42
    s_mov_b32 s50, s43
    s_mov_b32 s51, s45
    s_mov_b32 s52, s45
    s_mov_b32 s54, s43
    s_mov_b32 s55, s44
    s_add_u32 s90, s36, 49152
    s_mov_b32 s56, s90
    s_add_u32 s91, s36, 147456
    s_mov_b32 s57, 49152
    s_mov_b32 s58, 0
    s_mov_b32 s59, 12
    s_mov_b32 s60, 0
    s_cmp_lt_u32 s88, 72
    s_cbranch_scc1 L_skip20
    s_cbranch_vccnz L_cf21
    s_add_u32 s70, s37, 6291456
    s_add_u32 m0, s36, 73728
    s_nop 0
    buffer_load_dwordx4 v0, s[12:15], s70 offen offset:0 nt lds
    buffer_load_dwordx4 v1, s[12:15], s70 offen offset:1024 nt lds
    buffer_load_dwordx4 v2, s[12:15], s70 offen offset:2048 nt lds
    s_add_u32 s70, s37, 6291456
    s_add_u32 m0, s36, 76800
    s_nop 0
    buffer_load_dwordx4 v3, s[12:15], s70 offen offset:0 nt lds
    buffer_load_dwordx4 v4, s[12:15], s70 offen offset:1024 nt lds
    buffer_load_dwordx4 v5, s[12:15], s70 offen offset:2048 nt lds
L_cf21:
    s_cbranch_vccz L_cf24
    s_add_u32 s70, s37, 6291456
    s_add_u32 m0, s36, 73728
    s_nop 0
    buffer_load_dwordx4 v0, s[12:15], s70 offen offset:0 nt lds
    buffer_load_dwordx4 v1, s[12:15], s70 offen offset:1024 nt lds
    buffer_load_dwordx4 v2, s[12:15], s70 offen offset:2048 nt lds
    s_add_u32 s70, s37, 6291456
    s_add_u32 m0, s36, 76800
    s_nop 0
    buffer_load_dwordx4 v3, s[12:15], s70 offen offset:0 nt lds
    buffer_load_dwordx4 v4, s[12:15], s70 offen offset:1024 nt lds
    buffer_load_dwordx4 v5, s[12:15], s70 offen offset:2048 nt lds
L_cf24:
L_skip20:
    s_cmp_ge_u32 s88, 72
    s_cbranch_scc1 L_skip27
    v_lshrrev_b32 v88, 2, v86
    v_and_b32 v89, 3, v86
    v_lshl_add_u32 v90, v87, 3, v88
    v_lshlrev_b32 v90, 7, v90
    v_lshl_add_u32 v90, v89, 4, v90
    s_and_b32 s38, s3, 1
    s_lshl_b32 s38, s38, 3
    s_lshr_b32 s39, s3, 1
    s_lshl_b32 s39, s39, 6
    s_add_u32 s38, s38, s39
    v_add_u32 v106, s38, v90
    v_lshl_add_u32 v88, v88, 3, v89
    v_lshrrev_b32 v89, 1, v88
    v_mul_u32_u24 v90, 768, v88
    v_add_u32 v90, 98304, v90
    v_add_u32 v98, 0, v87
    v_xor_b32 v98, v98, v89
    v_lshl_add_u32 v98, v98, 4, v90
    v_add_u32 v99, 4, v87
    v_xor_b32 v99, v99, v89
    v_lshl_add_u32 v99, v99, 4, v90
    v_add_u32 v100, 8, v87
    v_xor_b32 v100, v100, v89
    v_lshl_add_u32 v100, v100, 4, v90
    v_add_u32 v101, 12, v87
    v_xor_b32 v101, v101, v89
    v_lshl_add_u32 v101, v101, 4, v90
    v_add_u32 v88, 4, v88
    v_lshrrev_b32 v89, 1, v88
    v_mul_u32_u24 v90, 768, v88
    v_add_u32 v90, 98304, v90
    v_add_u32 v102, 0, v87
    v_xor_b32 v102, v102, v89
    v_lshl_add_u32 v102, v102, 4, v90
    v_add_u32 v103, 4, v87
    v_xor_b32 v103, v103, v89
    v_lshl_add_u32 v103, v103, 4, v90
    v_add_u32 v104, 8, v87
    v_xor_b32 v104, v104, v89
    v_lshl_add_u32 v104, v104, 4, v90
    v_add_u32 v105, 12, v87
    v_xor_b32 v105, v105, v89
    v_lshl_add_u32 v105, v105, 4, v90
    v_lshlrev_b32 v107, 4, v84
    s_add_u32 s70, s37, 0
    s_add_u32 m0, s36, 49152
    s_nop 0
    buffer_load_dwordx4 v0, s[12:15], s70 offen offset:0 nt lds
    buffer_load_dwordx4 v1, s[12:15], s70 offen offset:1024 nt lds
    buffer_load_dwordx4 v2, s[12:15], s70 offen offset:2048 nt lds
    s_add_u32 s70, s37, 0
    s_add_u32 m0, s36, 52224
    s_nop 0
    buffer_load_dwordx4 v3, s[12:15], s70 offen offset:0 nt lds
    buffer_load_dwordx4 v4, s[12:15], s70 offen offset:1024 nt lds
    buffer_load_dwordx4 v5, s[12:15], s70 offen offset:2048 nt lds
    s_waitcnt vmcnt(6)
    s_barrier
    ds_read_b64_tr_b16 v[36:37], v106 offset:0
    ds_read_b64_tr_b16 v[38:39], v106 offset:512
    ds_read_b128 v[120:123], v98 offset:0
    ds_read_b128 v[124:127], v102 offset:0
    ds_read_b64_tr_b16 v[40:41], v106 offset:4096
    ds_read_b64_tr_b16 v[42:43], v106 offset:4608
    ds_read_b128 v[128:131], v99 offset:0
    ds_read_b128 v[132:135], v103 offset:0
    ds_read_b64_tr_b16 v[44:45], v106 offset:8192
    ds_read_b64_tr_b16 v[46:47], v106 offset:8704
    ds_read_b128 v[136:139], v100 offset:0
    ds_read_b128 v[140:143], v104 offset:0
    ds_read_b64_tr_b16 v[48:49], v106 offset:12288
    ds_read_b64_tr_b16 v[50:51], v106 offset:12800
    ds_read_b128 v[144:147], v101 offset:0
    ds_read_b128 v[148:151], v105 offset:0
    ds_read_b64_tr_b16 v[52:53], v106 offset:16384
    ds_read_b64_tr_b16 v[54:55], v106 offset:16896
    ds_read_b128 v[152:155], v98 offset:256
    ds_read_b128 v[156:159], v102 offset:256
    ds_read_b64_tr_b16 v[56:57], v106 offset:20480
    ds_read_b64_tr_b16 v[58:59], v106 offset:20992
    ds_read_b128 v[160:163], v99 offset:256
    ds_read_b128 v[164:167], v103 offset:256
    ds_read_b64_tr_b16 v[60:61], v106 offset:24576
    ds_read_b64_tr_b16 v[62:63], v106 offset:25088
    ds_read_b128 v[168:171], v100 offset:256
    ds_read_b128 v[172:175], v104 offset:256
    ds_read_b64_tr_b16 v[64:65], v106 offset:28672
    ds_read_b64_tr_b16 v[66:67], v106 offset:29184
    ds_read_b128 v[176:179], v101 offset:256
    ds_read_b128 v[180:183], v105 offset:256
    ds_read_b64_tr_b16 v[68:69], v106 offset:32768
    ds_read_b64_tr_b16 v[70:71], v106 offset:33280
    ds_read_b128 v[184:187], v98 offset:512
    ds_read_b128 v[188:191], v102 offset:512
    ds_read_b64_tr_b16 v[72:73], v106 offset:36864
    ds_read_b64_tr_b16 v[74:75], v106 offset:37376
    ds_read_b128 v[192:195], v99 offset:512
    ds_read_b128 v[196:199], v103 offset:512
    ds_read_b64_tr_b16 v[76:77], v106 offset:40960
    ds_read_b64_tr_b16 v[78:79], v106 offset:41472
    ds_read_b128 v[200:203], v100 offset:512
    ds_read_b128 v[204:207], v104 offset:512
    ds_read_b64_tr_b16 v[80:81], v106 offset:45056
    ds_read_b64_tr_b16 v[82:83], v106 offset:45568
    ds_read_b128 v[208:211], v101 offset:512
    ds_read_b128 v[212:215], v105 offset:512
    s_add_u32 s70, s37, 6291456
    s_add_u32 m0, s36, 73728
    s_nop 0
    buffer_load_dwordx4 v0, s[12:15], s70 offen offset:0 nt lds
    buffer_load_dwordx4 v1, s[12:15], s70 offen offset:1024 nt lds
    buffer_load_dwordx4 v2, s[12:15], s70 offen offset:2048 nt lds
    s_add_u32 s70, s37, 6291456
    s_add_u32 m0, s36, 76800
    s_nop 0
    buffer_load_dwordx4 v3, s[12:15], s70 offen offset:0 nt lds
    buffer_load_dwordx4 v4, s[12:15], s70 offen offset:1024 nt lds
    buffer_load_dwordx4 v5, s[12:15], s70 offen offset:2048 nt lds
    s_waitcnt lgkmcnt(15)
    v_mfma_f32_16x16x32_bf16 v[16:19], v[120:123], v[36:39], 0
    v_mfma_f32_16x16x32_bf16 v[20:23], v[124:127], v[36:39], 0
    s_waitcnt lgkmcnt(15)
    v_mfma_f32_16x16x32_bf16 v[16:19], v[128:131], v[40:43], v[16:19]
    v_mfma_f32_16x16x32_bf16 v[20:23], v[132:135], v[40:43], v[20:23]
    s_waitcnt lgkmcnt(15)
    v_mfma_f32_16x16x32_bf16 v[16:19], v[136:139], v[44:47], v[16:19]
    v_mfma_f32_16x16x32_bf16 v[20:23], v[140:143], v[44:47], v[20:23]
    s_waitcnt lgkmcnt(15)
    v_mfma_f32_16x16x32_bf16 v[16:19], v[144:147], v[48:51], v[16:19]
    v_mfma_f32_16x16x32_bf16 v[20:23], v[148:151], v[48:51], v[20:23]
    s_waitcnt lgkmcnt(15)
    v_mfma_f32_16x16x32_bf16 v[16:19], v[152:155], v[52:55], v[16:19]
    v_mfma_f32_16x16x32_bf16 v[20:23], v[156:159], v[52:55], v[20:23]
    s_waitcnt lgkmcnt(15)
    v_mfma_f32_16x16x32_bf16 v[16:19], v[160:163], v[56:59], v[16:19]
    v_mfma_f32_16x16x32_bf16 v[20:23], v[164:167], v[56:59], v[20:23]
    s_waitcnt lgkmcnt(15)
    v_mfma_f32_16x16x32_bf16 v[16:19], v[168:171], v[60:63], v[16:19]
    v_mfma_f32_16x16x32_bf16 v[20:23], v[172:175], v[60:63], v[20:23]
    s_waitcnt lgkmcnt(15)
    v_mfma_f32_16x16x32_bf16 v[16:19], v[176:179], v[64:67], v[16:19]
    v_mfma_f32_16x16x32_bf16 v[20:23], v[180:183], v[64:67], v[20:23]
    s_waitcnt lgkmcnt(12)
    v_mfma_f32_16x16x32_bf16 v[16:19], v[184:187], v[68:71], v[16:19]
    v_mfma_f32_16x16x32_bf16 v[20:23], v[188:191], v[68:71], v[20:23]
    s_waitcnt lgkmcnt(8)
    v_mfma_f32_16x16x32_bf16 v[16:19], v[192:195], v[72:75], v[16:19]
    v_mfma_f32_16x16x32_bf16 v[20:23], v[196:199], v[72:75], v[20:23]
    s_waitcnt lgkmcnt(4)
    v_mfma_f32_16x16x32_bf16 v[16:19], v[200:203], v[76:79], v[16:19]
    v_mfma_f32_16x16x32_bf16 v[20:23], v[204:207], v[76:79], v[20:23]
    s_waitcnt lgkmcnt(0)
    v_mfma_f32_16x16x32_bf16 v[16:19], v[208:211], v[80:83], v[16:19]
    v_mfma_f32_16x16x32_bf16 v[20:23], v[212:215], v[80:83], v[20:23]
    s_barrier
    s_nop 7
    v_cvt_pk_bf16_f32 v24, v16, v17
    v_cvt_pk_bf16_f32 v25, v18, v19
    v_cvt_pk_bf16_f32 v26, v20, v21
    v_cvt_pk_bf16_f32 v27, v22, v23
    buffer_store_dwordx4 v[24:27], v107, s[16:19], s87 offen sc1
L_skip27:
    s_mov_b32 s38, 0
    s_add_u32 m0, s36, 122880
    s_nop 0
    buffer_load_dwordx4 v108, s[24:27], s38 offen offset:0 lds
    buffer_load_dwordx4 v109, s[24:27], s38 offen offset:1024 lds
    buffer_load_dwordx4 v110, s[24:27], s38 offen offset:2048 lds
    s_add_u32 m0, s36, 125952
    s_nop 0
    buffer_load_dwordx4 v111, s[24:27], s38 offen offset:0 lds
    buffer_load_dwordx4 v112, s[24:27], s38 offen offset:1024 lds
    buffer_load_dwordx4 v113, s[24:27], s38 offen offset:2048 lds
    s_mov_b32 s38, 24576
    s_add_u32 m0, s36, 0
    s_nop 0
    buffer_load_dwordx4 v108, s[24:27], s38 offen offset:0 lds
    buffer_load_dwordx4 v109, s[24:27], s38 offen offset:1024 lds
    buffer_load_dwordx4 v110, s[24:27], s38 offen offset:2048 lds
    s_add_u32 m0, s36, 3072
    s_nop 0
    buffer_load_dwordx4 v111, s[24:27], s38 offen offset:0 lds
    buffer_load_dwordx4 v112, s[24:27], s38 offen offset:1024 lds
    buffer_load_dwordx4 v113, s[24:27], s38 offen offset:2048 lds
    s_cmp_lg_u32 s89, 0
    s_cbranch_scc1 L_kw13_0
    s_waitcnt vmcnt(18)
L_kw13_0:
    s_cmp_lg_u32 s89, 1
    s_cbranch_scc1 L_kw13_1
    s_waitcnt vmcnt(18)
L_kw13_1:
    s_cmp_lg_u32 s89, 2
    s_cbranch_scc1 L_kw13_2
    s_waitcnt vmcnt(19)
L_kw13_2:
    s_barrier
    ds_read_b128 v[16:19], v32 offset:0
    ds_read_b128 v[20:23], v34 offset:12288
    ds_read_b128 v[24:27], v33 offset:0
    s_waitcnt vmcnt(6)
    ds_read_b64_tr_b16 a[0:1], v95 offset:49152
    ds_read_b64_tr_b16 a[2:3], v95 offset:49920
    ds_read_b64_tr_b16 a[4:5], v95 offset:49160
    ds_read_b64_tr_b16 a[6:7], v95 offset:49928
    ds_read_b64_tr_b16 a[8:9], v96 offset:49152
    ds_read_b64_tr_b16 a[10:11], v96 offset:49920
    ds_read_b64_tr_b16 a[12:13], v96 offset:49160
    ds_read_b64_tr_b16 a[14:15], v96 offset:49928
    ds_read_b64_tr_b16 a[16:17], v97 offset:49152
    ds_read_b64_tr_b16 a[18:19], v97 offset:49920
    ds_read_b64_tr_b16 a[20:21], v97 offset:49160
    ds_read_b64_tr_b16 a[22:23], v97 offset:49928
    s_mov_b32 s38, 49152
    s_add_u32 m0, s36, 24576
    s_nop 0
    buffer_load_dwordx4 v108, s[24:27], s38 offen offset:0 lds
    buffer_load_dwordx4 v109, s[24:27], s38 offen offset:1024 lds
    buffer_load_dwordx4 v110, s[24:27], s38 offen offset:2048 lds
    s_add_u32 m0, s36, 27648
    s_nop 0
    buffer_load_dwordx4 v111, s[24:27], s38 offen offset:0 lds
    buffer_load_dwordx4 v112, s[24:27], s38 offen offset:1024 lds
    buffer_load_dwordx4 v113, s[24:27], s38 offen offset:2048 lds
    s_waitcnt lgkmcnt(14)
    s_waitcnt lgkmcnt(0)
    s_mov_b32 s38, 73728
    s_add_u32 m0, s36, 122880
    s_nop 0
    buffer_load_dwordx4 v108, s[24:27], s38 offen offset:0 lds
    buffer_load_dwordx4 v109, s[24:27], s38 offen offset:1024 lds
    buffer_load_dwordx4 v110, s[24:27], s38 offen offset:2048 lds
    s_add_u32 m0, s36, 125952
    s_nop 0
    buffer_load_dwordx4 v111, s[24:27], s38 offen offset:0 lds
    buffer_load_dwordx4 v112, s[24:27], s38 offen offset:1024 lds
    buffer_load_dwordx4 v113, s[24:27], s38 offen offset:2048 lds
    s_waitcnt vmcnt(12)
    ds_read_b64_tr_b16 a[24:25], v92 offset:0
    ds_read_b64_tr_b16 a[26:27], v92 offset:768
    ds_read_b64_tr_b16 a[28:29], v92 offset:8
    ds_read_b64_tr_b16 a[30:31], v92 offset:776
    ds_read_b64_tr_b16 a[32:33], v93 offset:0
    ds_read_b64_tr_b16 a[34:35], v93 offset:768
    ds_read_b64_tr_b16 a[36:37], v93 offset:8
    ds_read_b64_tr_b16 a[38:39], v93 offset:776
    ds_read_b64_tr_b16 a[40:41], v94 offset:0
    ds_read_b64_tr_b16 a[42:43], v94 offset:768
    ds_read_b64_tr_b16 a[44:45], v94 offset:8
    ds_read_b64_tr_b16 a[46:47], v94 offset:776
    v_mfma_f32_16x16x32_bf16 v[168:171], a[0:3], v[16:19], 0
    ds_read_b128 v[28:31], v35 offset:12288
    v_mfma_f32_16x16x32_bf16 v[172:175], a[4:7], v[16:19], 0
    v_mfma_f32_16x16x32_bf16 v[176:179], a[8:11], v[16:19], 0
    v_mfma_f32_16x16x32_bf16 v[180:183], a[12:15], v[16:19], 0
    v_mfma_f32_16x16x32_bf16 v[184:187], a[16:19], v[16:19], 0
    v_mfma_f32_16x16x32_bf16 v[188:191], a[20:23], v[16:19], 0
    v_mfma_f32_16x16x32_bf16 v[192:195], a[0:3], v[20:23], 0
    ds_read_b128 v[16:19], v34 offset:0
    v_mfma_f32_16x16x32_bf16 v[196:199], a[4:7], v[20:23], 0
    v_mfma_f32_16x16x32_bf16 v[200:203], a[8:11], v[20:23], 0
    v_mfma_f32_16x16x32_bf16 v[204:207], a[12:15], v[20:23], 0
    v_mfma_f32_16x16x32_bf16 v[208:211], a[16:19], v[20:23], 0
    v_mfma_f32_16x16x32_bf16 v[212:215], a[20:23], v[20:23], 0
    s_waitcnt lgkmcnt(2)
    s_mov_b32 s38, 98304
    s_add_u32 m0, s36, 0
    s_nop 0
    buffer_load_dwordx4 v108, s[24:27], s38 offen offset:0 lds
    buffer_load_dwordx4 v109, s[24:27], s38 offen offset:1024 lds
    buffer_load_dwordx4 v110, s[24:27], s38 offen offset:2048 lds
    s_add_u32 m0, s36, 3072
    s_nop 0
    buffer_load_dwordx4 v111, s[24:27], s38 offen offset:0 lds
    buffer_load_dwordx4 v112, s[24:27], s38 offen offset:1024 lds
    buffer_load_dwordx4 v113, s[24:27], s38 offen offset:2048 lds
    s_waitcnt vmcnt(12)
    ds_read_b64_tr_b16 a[48:49], v92 offset:24576
    ds_read_b64_tr_b16 a[50:51], v92 offset:25344
    ds_read_b64_tr_b16 a[52:53], v92 offset:24584
    ds_read_b64_tr_b16 a[54:55], v92 offset:25352
    ds_read_b64_tr_b16 a[56:57], v93 offset:24576
    ds_read_b64_tr_b16 a[58:59], v93 offset:25344
    ds_read_b64_tr_b16 a[60:61], v93 offset:24584
    ds_read_b64_tr_b16 a[62:63], v93 offset:25352
    ds_read_b64_tr_b16 a[64:65], v94 offset:24576
    ds_read_b64_tr_b16 a[66:67], v94 offset:25344
    ds_read_b64_tr_b16 a[68:69], v94 offset:24584
    ds_read_b64_tr_b16 a[70:71], v94 offset:25352
    v_mfma_f32_16x16x32_bf16 v[168:171], a[24:27], v[24:27], v[168:171]
    ds_read_b128 v[20:23], v32 offset:12288
    v_mfma_f32_16x16x32_bf16 v[172:175], a[28:31], v[24:27], v[172:175]
    v_mfma_f32_16x16x32_bf16 v[176:179], a[32:35], v[24:27], v[176:179]
    v_mfma_f32_16x16x32_bf16 v[180:183], a[36:39], v[24:27], v[180:183]
    v_mfma_f32_16x16x32_bf16 v[184:187], a[40:43], v[24:27], v[184:187]
    v_mfma_f32_16x16x32_bf16 v[188:191], a[44:47], v[24:27], v[188:191]
    s_waitcnt lgkmcnt(14)
    v_mfma_f32_16x16x32_bf16 v[192:195], a[24:27], v[28:31], v[192:195]
    ds_read_b128 v[24:27], v35 offset:0
    v_mfma_f32_16x16x32_bf16 v[196:199], a[28:31], v[28:31], v[196:199]
    v_mfma_f32_16x16x32_bf16 v[200:203], a[32:35], v[28:31], v[200:203]
    v_mfma_f32_16x16x32_bf16 v[204:207], a[36:39], v[28:31], v[204:207]
    v_mfma_f32_16x16x32_bf16 v[208:211], a[40:43], v[28:31], v[208:211]
    v_mfma_f32_16x16x32_bf16 v[212:215], a[44:47], v[28:31], v[212:215]
    s_waitcnt lgkmcnt(14)
    s_waitcnt lgkmcnt(2)
    s_mov_b32 s38, 122880
    s_add_u32 m0, s36, 24576
    s_nop 0
    buffer_load_dwordx4 v108, s[24:27], s38 offen offset:0 lds
    buffer_load_dwordx4 v109, s[24:27], s38 offen offset:1024 lds
    buffer_load_dwordx4 v110, s[24:27], s38 offen offset:2048 lds
    s_add_u32 m0, s36, 27648
    s_nop 0
    buffer_load_dwordx4 v111, s[24:27], s38 offen offset:0 lds
    buffer_load_dwordx4 v112, s[24:27], s38 offen offset:1024 lds
    buffer_load_dwordx4 v113, s[24:27], s38 offen offset:2048 lds
    s_waitcnt vmcnt(12)
    ds_read_b64_tr_b16 a[72:73], v95 offset:49152
    ds_read_b64_tr_b16 a[74:75], v95 offset:49920
    ds_read_b64_tr_b16 a[76:77], v95 offset:49160
    ds_read_b64_tr_b16 a[78:79], v95 offset:49928
    ds_read_b64_tr_b16 a[80:81], v96 offset:49152
    ds_read_b64_tr_b16 a[82:83], v96 offset:49920
    ds_read_b64_tr_b16 a[84:85], v96 offset:49160
    ds_read_b64_tr_b16 a[86:87], v96 offset:49928
    ds_read_b64_tr_b16 a[88:89], v97 offset:49152
    ds_read_b64_tr_b16 a[90:91], v97 offset:49920
    ds_read_b64_tr_b16 a[92:93], v97 offset:49160
    ds_read_b64_tr_b16 a[94:95], v97 offset:49928
    s_cmp_ge_u32 s88, 72
    s_cbranch_scc1 L_skip56
    s_barrier
    s_cmp_lg_u32 s3, 0
    s_cbranch_scc1 L_nosig
    s_mov_b64 exec, 1
    buffer_atomic_add v221, off, s[32:35], 0 sc1
    s_mov_b64 exec, -1
    s_nop 3
L_nosig:
L_skip56:
    v_mfma_f32_16x16x32_bf16 v[168:171], a[48:51], v[16:19], v[168:171]
    ds_read_b128 v[28:31], v33 offset:12288
    v_mfma_f32_16x16x32_bf16 v[172:175], a[52:55], v[16:19], v[172:175]
    v_mfma_f32_16x16x32_bf16 v[176:179], a[56:59], v[16:19], v[176:179]
    v_mfma_f32_16x16x32_bf16 v[180:183], a[60:63], v[16:19], v[180:183]
    v_mfma_f32_16x16x32_bf16 v[184:187], a[64:67], v[16:19], v[184:187]
    v_mfma_f32_16x16x32_bf16 v[188:191], a[68:71], v[16:19], v[188:191]
    s_waitcnt lgkmcnt(14)
    v_mfma_f32_16x16x32_bf16 v[192:195], a[48:51], v[20:23], v[192:195]
    ds_read_b128 v[16:19], v32 offset:256
    v_mfma_f32_16x16x32_bf16 v[196:199], a[52:55], v[20:23], v[196:199]
    v_mfma_f32_16x16x32_bf16 v[200:203], a[56:59], v[20:23], v[200:203]
    v_mfma_f32_16x16x32_bf16 v[204:207], a[60:63], v[20:23], v[204:207]
    v_mfma_f32_16x16x32_bf16 v[208:211], a[64:67], v[20:23], v[208:211]
    v_mfma_f32_16x16x32_bf16 v[212:215], a[68:71], v[20:23], v[212:215]
    s_waitcnt lgkmcnt(14)
    s_waitcnt lgkmcnt(2)
    s_mov_b32 s38, 147456
    s_add_u32 m0, s36, 122880
    s_nop 0
    buffer_load_dwordx4 v108, s[24:27], s38 offen offset:0 lds
    buffer_load_dwordx4 v109, s[24:27], s38 offen offset:1024 lds
    buffer_load_dwordx4 v110, s[24:27], s38 offen offset:2048 lds
    s_add_u32 m0, s36, 125952
    s_nop 0
    buffer_load_dwordx4 v111, s[24:27], s38 offen offset:0 lds
    buffer_load_dwordx4 v112, s[24:27], s38 offen offset:1024 lds
    buffer_load_dwordx4 v113, s[24:27], s38 offen offset:2048 lds
    s_waitcnt vmcnt(12)
    ds_read_b64_tr_b16 a[96:97], v92 offset:0
    ds_read_b64_tr_b16 a[98:99], v92 offset:768
    ds_read_b64_tr_b16 a[100:101], v92 offset:8
    ds_read_b64_tr_b16 a[102:103], v92 offset:776
    ds_read_b64_tr_b16 a[104:105], v93 offset:0
    ds_read_b64_tr_b16 a[106:107], v93 offset:768
    ds_read_b64_tr_b16 a[108:109], v93 offset:8
    ds_read_b64_tr_b16 a[110:111], v93 offset:776
    ds_read_b64_tr_b16 a[112:113], v94 offset:0
    ds_read_b64_tr_b16 a[114:115], v94 offset:768
    ds_read_b64_tr_b16 a[116:117], v94 offset:8
    ds_read_b64_tr_b16 a[118:119], v94 offset:776
    v_mfma_f32_16x16x32_bf16 v[168:171], a[72:75], v[24:27], v[168:171]
    ds_read_b128 v[20:23], v34 offset:12544
    v_mfma_f32_16x16x32_bf16 v[172:175], a[76:79], v[24:27], v[172:175]
    v_mfma_f32_16x16x32_bf16 v[176:179], a[80:83], v[24:27], v[176:179]
    v_mfma_f32_16x16x32_bf16 v[180:183], a[84:87], v[24:27], v[180:183]
    v_mfma_f32_16x16x32_bf16 v[184:187], a[88:91], v[24:27], v[184:187]
    v_mfma_f32_16x16x32_bf16 v[188:191], a[92:95], v[24:27], v[188:191]
    s_waitcnt lgkmcnt(14)
    v_mfma_f32_16x16x32_bf16 v[192:195], a[72:75], v[28:31], v[192:195]
    ds_read_b128 v[24:27], v33 offset:256
    v_mfma_f32_16x16x32_bf16 v[196:199], a[76:79], v[28:31], v[196:199]
    v_mfma_f32_16x16x32_bf16 v[200:203], a[80:83], v[28:31], v[200:203]
    v_mfma_f32_16x16x32_bf16 v[204:207], a[84:87], v[28:31], v[204:207]
    v_mfma_f32_16x16x32_bf16 v[208:211], a[88:91], v[28:31], v[208:211]
    v_mfma_f32_16x16x32_bf16 v[212:215], a[92:95], v[28:31], v[212:215]
    s_waitcnt lgkmcnt(14)
    s_waitcnt lgkmcnt(2)
    s_mov_b32 s38, 172032
    s_add_u32 m0, s36, 0
    s_nop 0
    buffer_load_dwordx4 v108, s[24:27], s38 offen offset:0 lds
    buffer_load_dwordx4 v109, s[24:27], s38 offen offset:1024 lds
    buffer_load_dwordx4 v110, s[24:27], s38 offen offset:2048 lds
    s_add_u32 m0, s36, 3072
    s_nop 0
    buffer_load_dwordx4 v111, s[24:27], s38 offen offset:0 lds
    buffer_load_dwordx4 v112, s[24:27], s38 offen offset:1024 lds
    buffer_load_dwordx4 v113, s[24:27], s38 offen offset:2048 lds
    s_waitcnt vmcnt(12)
    ds_read_b64_tr_b16 a[120:121], v92 offset:24576
    ds_read_b64_tr_b16 a[122:123], v92 offset:25344
    ds_read_b64_tr_b16 a[124:125], v92 offset:24584
    ds_read_b64_tr_b16 a[126:127], v92 offset:25352
    ds_read_b64_tr_b16 a[128:129], v93 offset:24576
    ds_read_b64_tr_b16 a[130:131], v93 offset:25344
    ds_read_b64_tr_b16 a[132:133], v93 offset:24584
    ds_read_b64_tr_b16 a[134:135], v93 offset:25352
    ds_read_b64_tr_b16 a[136:137], v94 offset:24576
    ds_read_b64_tr_b16 a[138:139], v94 offset:25344
    ds_read_b64_tr_b16 a[140:141], v94 offset:24584
    ds_read_b64_tr_b16 a[142:143], v94 offset:25352
    v_mfma_f32_16x16x32_bf16 v[168:171], a[96:99], v[16:19], v[168:171]
    ds_read_b128 v[28:31], v35 offset:12544
    v_mfma_f32_16x16x32_bf16 v[172:175], a[100:103], v[16:19], v[172:175]
    v_mfma_f32_16x16x32_bf16 v[176:179], a[104:107], v[16:19], v[176:179]
    v_mfma_f32_16x16x32_bf16 v[180:183], a[108:111], v[16:19], v[180:183]
    v_mfma_f32_16x16x32_bf16 v[184:187], a[112:115], v[16:19], v[184:187]
    v_mfma_f32_16x16x32_bf16 v[188:191], a[116:119], v[16:19], v[188:191]
    s_waitcnt lgkmcnt(14)
    v_mfma_f32_16x16x32_bf16 v[192:195], a[96:99], v[20:23], v[192:195]
    ds_read_b128 v[16:19], v34 offset:256
    v_mfma_f32_16x16x32_bf16 v[196:199], a[100:103], v[20:23], v[196:199]
    v_mfma_f32_16x16x32_bf16 v[200:203], a[104:107], v[20:23], v[200:203]
    v_mfma_f32_16x16x32_bf16 v[204:207], a[108:111], v[20:23], v[204:207]
    v_mfma_f32_16x16x32_bf16 v[208:211], a[112:115], v[20:23], v[208:211]
    v_mfma_f32_16x16x32_bf16 v[212:215], a[116:119], v[20:23], v[212:215]
    s_waitcnt lgkmcnt(14)
    s_waitcnt lgkmcnt(2)
    s_mov_b32 s38, 196608
    s_add_u32 m0, s36, 24576
    s_nop 0
    buffer_load_dwordx4 v108, s[24:27], s38 offen offset:0 lds
    buffer_load_dwordx4 v109, s[24:27], s38 offen offset:1024 lds
    buffer_load_dwordx4 v110, s[24:27], s38 offen offset:2048 lds
    s_add_u32 m0, s36, 27648
    s_nop 0
    buffer_load_dwordx4 v111, s[24:27], s38 offen offset:0 lds
    buffer_load_dwordx4 v112, s[24:27], s38 offen offset:1024 lds
    buffer_load_dwordx4 v113, s[24:27], s38 offen offset:2048 lds
    s_waitcnt vmcnt(12)
    ds_read_b64_tr_b16 a[144:145], v95 offset:49152
    ds_read_b64_tr_b16 a[146:147], v95 offset:49920
    ds_read_b64_tr_b16 a[148:149], v95 offset:49160
    ds_read_b64_tr_b16 a[150:151], v95 offset:49928
    ds_read_b64_tr_b16 a[152:153], v96 offset:49152
    ds_read_b64_tr_b16 a[154:155], v96 offset:49920
    ds_read_b64_tr_b16 a[156:157], v96 offset:49160
    ds_read_b64_tr_b16 a[158:159], v96 offset:49928
    ds_read_b64_tr_b16 a[160:161], v97 offset:49152
    ds_read_b64_tr_b16 a[162:163], v97 offset:49920
    ds_read_b64_tr_b16 a[164:165], v97 offset:49160
    ds_read_b64_tr_b16 a[166:167], v97 offset:49928
    v_mfma_f32_16x16x32_bf16 v[168:171], a[120:123], v[24:27], v[168:171]
    ds_read_b128 v[20:23], v32 offset:12544
    v_mfma_f32_16x16x32_bf16 v[172:175], a[124:127], v[24:27], v[172:175]
    v_mfma_f32_16x16x32_bf16 v[176:179], a[128:131], v[24:27], v[176:179]
    v_mfma_f32_16x16x32_bf16 v[180:183], a[132:135], v[24:27], v[180:183]
    v_mfma_f32_16x16x32_bf16 v[184:187], a[136:139], v[24:27], v[184:187]
    v_mfma_f32_16x16x32_bf16 v[188:191], a[140:143], v[24:27], v[188:191]
    s_waitcnt lgkmcnt(14)
    v_mfma_f32_16x16x32_bf16 v[192:195], a[120:123], v[28:31], v[192:195]
    ds_read_b128 v[24:27], v35 offset:256
    v_mfma_f32_16x16x32_bf16 v[196:199], a[124:127], v[28:31], v[196:199]
    v_mfma_f32_16x16x32_bf16 v[200:203], a[128:131], v[28:31], v[200:203]
    v_mfma_f32_16x16x32_bf16 v[204:207], a[132:135], v[28:31], v[204:207]
    v_mfma_f32_16x16x32_bf16 v[208:211], a[136:139], v[28:31], v[208:211]
    v_mfma_f32_16x16x32_bf16 v[212:215], a[140:143], v[28:31], v[212:215]
    s_waitcnt lgkmcnt(14)
    s_waitcnt lgkmcnt(2)
    s_mov_b32 s38, 221184
    s_add_u32 m0, s36, 122880
    s_nop 0
    buffer_load_dwordx4 v108, s[24:27], s38 offen offset:0 lds
    buffer_load_dwordx4 v109, s[24:27], s38 offen offset:1024 lds
    buffer_load_dwordx4 v110, s[24:27], s38 offen offset:2048 lds
    s_add_u32 m0, s36, 125952
    s_nop 0
    buffer_load_dwordx4 v111, s[24:27], s38 offen offset:0 lds
    buffer_load_dwordx4 v112, s[24:27], s38 offen offset:1024 lds
    buffer_load_dwordx4 v113, s[24:27], s38 offen offset:2048 lds
    s_waitcnt vmcnt(12)
    ds_read_b64_tr_b16 a[168:169], v92 offset:0
    ds_read_b64_tr_b16 a[170:171], v92 offset:768
    ds_read_b64_tr_b16 a[172:173], v92 offset:8
    ds_read_b64_tr_b16 a[174:175], v92 offset:776
    ds_read_b64_tr_b16 a[176:177], v93 offset:0
    ds_read_b64_tr_b16 a[178:179], v93 offset:768
    ds_read_b64_tr_b16 a[180:181], v93 offset:8
    ds_read_b64_tr_b16 a[182:183], v93 offset:776
    ds_read_b64_tr_b16 a[184:185], v94 offset:0
    ds_read_b64_tr_b16 a[186:187], v94 offset:768
    ds_read_b64_tr_b16 a[188:189], v94 offset:8
    ds_read_b64_tr_b16 a[190:191], v94 offset:776
    v_mfma_f32_16x16x32_bf16 v[168:171], a[144:147], v[16:19], v[168:171]
    ds_read_b128 v[28:31], v33 offset:12544
    v_mfma_f32_16x16x32_bf16 v[172:175], a[148:151], v[16:19], v[172:175]
    v_mfma_f32_16x16x32_bf16 v[176:179], a[152:155], v[16:19], v[176:179]
    v_mfma_f32_16x16x32_bf16 v[180:183], a[156:159], v[16:19], v[180:183]
    v_mfma_f32_16x16x32_bf16 v[184:187], a[160:163], v[16:19], v[184:187]
    v_mfma_f32_16x16x32_bf16 v[188:191], a[164:167], v[16:19], v[188:191]
    s_waitcnt lgkmcnt(14)
    v_mfma_f32_16x16x32_bf16 v[192:195], a[144:147], v[20:23], v[192:195]
    ds_read_b128 v[16:19], v32 offset:512
    v_mfma_f32_16x16x32_bf16 v[196:199], a[148:151], v[20:23], v[196:199]
    v_mfma_f32_16x16x32_bf16 v[200:203], a[152:155], v[20:23], v[200:203]
    v_mfma_f32_16x16x32_bf16 v[204:207], a[156:159], v[20:23], v[204:207]
    v_mfma_f32_16x16x32_bf16 v[208:211], a[160:163], v[20:23], v[208:211]
    v_mfma_f32_16x16x32_bf16 v[212:215], a[164:167], v[20:23], v[212:215]
    s_waitcnt lgkmcnt(14)
    s_waitcnt lgkmcnt(2)
    s_mov_b32 s38, 245760
    s_add_u32 m0, s36, 0
    s_nop 0
    buffer_load_dwordx4 v108, s[24:27], s38 offen offset:0 lds
    buffer_load_dwordx4 v109, s[24:27], s38 offen offset:1024 lds
    buffer_load_dwordx4 v110, s[24:27], s38 offen offset:2048 lds
    s_add_u32 m0, s36, 3072
    s_nop 0
    buffer_load_dwordx4 v111, s[24:27], s38 offen offset:0 lds
    buffer_load_dwordx4 v112, s[24:27], s38 offen offset:1024 lds
    buffer_load_dwordx4 v113, s[24:27], s38 offen offset:2048 lds
    s_waitcnt vmcnt(12)
    ds_read_b64_tr_b16 a[192:193], v92 offset:24576
    ds_read_b64_tr_b16 a[194:195], v92 offset:25344
    ds_read_b64_tr_b16 a[196:197], v92 offset:24584
    ds_read_b64_tr_b16 a[198:199], v92 offset:25352
    ds_read_b64_tr_b16 a[200:201], v93 offset:24576
    ds_read_b64_tr_b16 a[202:203], v93 offset:25344
    ds_read_b64_tr_b16 a[204:205], v93 offset:24584
    ds_read_b64_tr_b16 a[206:207], v93 offset:25352
    ds_read_b64_tr_b16 a[208:209], v94 offset:24576
    ds_read_b64_tr_b16 a[210:211], v94 offset:25344
    ds_read_b64_tr_b16 a[212:213], v94 offset:24584
    ds_read_b64_tr_b16 a[214:215], v94 offset:25352
    v_mfma_f32_16x16x32_bf16 v[168:171], a[168:171], v[24:27], v[168:171]
    ds_read_b128 v[20:23], v34 offset:12800
    v_mfma_f32_16x16x32_bf16 v[172:175], a[172:175], v[24:27], v[172:175]
    v_mfma_f32_16x16x32_bf16 v[176:179], a[176:179], v[24:27], v[176:179]
    v_mfma_f32_16x16x32_bf16 v[180:183], a[180:183], v[24:27], v[180:183]
    v_mfma_f32_16x16x32_bf16 v[184:187], a[184:187], v[24:27], v[184:187]
    v_mfma_f32_16x16x32_bf16 v[188:191], a[188:191], v[24:27], v[188:191]
    s_waitcnt lgkmcnt(14)
    v_mfma_f32_16x16x32_bf16 v[192:195], a[168:171], v[28:31], v[192:195]
    ds_read_b128 v[24:27], v33 offset:512
    v_mfma_f32_16x16x32_bf16 v[196:199], a[172:175], v[28:31], v[196:199]
    v_mfma_f32_16x16x32_bf16 v[200:203], a[176:179], v[28:31], v[200:203]
    v_mfma_f32_16x16x32_bf16 v[204:207], a[180:183], v[28:31], v[204:207]
    v_mfma_f32_16x16x32_bf16 v[208:211], a[184:187], v[28:31], v[208:211]
    v_mfma_f32_16x16x32_bf16 v[212:215], a[188:191], v[28:31], v[212:215]
    s_waitcnt lgkmcnt(14)
    s_waitcnt lgkmcnt(2)
    s_mov_b32 s38, 270336
    s_add_u32 m0, s36, 24576
    s_nop 0
    buffer_load_dwordx4 v108, s[24:27], s38 offen offset:0 lds
    buffer_load_dwordx4 v109, s[24:27], s38 offen offset:1024 lds
    buffer_load_dwordx4 v110, s[24:27], s38 offen offset:2048 lds
    s_add_u32 m0, s36, 27648
    s_nop 0
    buffer_load_dwordx4 v111, s[24:27], s38 offen offset:0 lds
    buffer_load_dwordx4 v112, s[24:27], s38 offen offset:1024 lds
    buffer_load_dwordx4 v113, s[24:27], s38 offen offset:2048 lds
    s_waitcnt vmcnt(12)
    ds_read_b64_tr_b16 a[216:217], v95 offset:49152
    ds_read_b64_tr_b16 a[218:219], v95 offset:49920
    ds_read_b64_tr_b16 a[220:221], v95 offset:49160
    ds_read_b64_tr_b16 a[222:223], v95 offset:49928
    ds_read_b64_tr_b16 a[224:225], v96 offset:49152
    ds_read_b64_tr_b16 a[226:227], v96 offset:49920
    ds_read_b64_tr_b16 a[228:229], v96 offset:49160
    ds_read_b64_tr_b16 a[230:231], v96 offset:49928
    ds_read_b64_tr_b16 a[232:233], v97 offset:49152
    ds_read_b64_tr_b16 a[234:235], v97 offset:49920
    ds_read_b64_tr_b16 a[236:237], v97 offset:49160
    ds_read_b64_tr_b16 a[238:239], v97 offset:49928
    v_mfma_f32_16x16x32_bf16 v[168:171], a[192:195], v[16:19], v[168:171]
    ds_read_b128 v[28:31], v35 offset:12800
    v_mfma_f32_16x16x32_bf16 v[172:175], a[196:199], v[16:19], v[172:175]
    v_mfma_f32_16x16x32_bf16 v[176:179], a[200:203], v[16:19], v[176:179]
    v_mfma_f32_16x16x32_bf16 v[180:183], a[204:207], v[16:19], v[180:183]
    v_mfma_f32_16x16x32_bf16 v[184:187], a[208:211], v[16:19], v[184:187]
    v_mfma_f32_16x16x32_bf16 v[188:191], a[212:215], v[16:19], v[188:191]
    s_waitcnt lgkmcnt(14)
    v_mfma_f32_16x16x32_bf16 v[192:195], a[192:195], v[20:23], v[192:195]
    ds_read_b128 v[16:19], v34 offset:512
    v_mfma_f32_16x16x32_bf16 v[196:199], a[196:199], v[20:23], v[196:199]
    s_mov_b32 s72, s12
    s_mov_b32 s73, s13
    s_mov_b32 s74, s14
    s_add_u32 s76, s37, 12582912
    s_add_u32 s77, s36, 147456
    s_cmp_lt_u32 s3, 2
    s_cselect_b32 s76, s76, 0x80000000
    s_cselect_b32 s77, s77, 0x30000
    v_mfma_f32_16x16x32_bf16 v[200:203], a[200:203], v[20:23], v[200:203]
    s_add_u32 m0, s77, 0
    s_nop 0
    buffer_load_dwordx4 v0, s[72:75], s76 offen offset:0 nt lds
    v_mfma_f32_16x16x32_bf16 v[204:207], a[204:207], v[20:23], v[204:207]
    v_mfma_f32_16x16x32_bf16 v[208:211], a[208:211], v[20:23], v[208:211]
    s_add_u32 m0, s77, 0
    s_nop 0
    buffer_load_dwordx4 v1, s[72:75], s76 offen offset:1024 nt lds
    v_mfma_f32_16x16x32_bf16 v[212:215], a[212:215], v[20:23], v[212:215]
    s_waitcnt lgkmcnt(14)
    s_waitcnt lgkmcnt(2)
    s_waitcnt vmcnt(8)
    ds_read_b64_tr_b16 a[240:241], v92 offset:0
    ds_read_b64_tr_b16 a[242:243], v92 offset:768
    ds_read_b64_tr_b16 a[244:245], v92 offset:8
    ds_read_b64_tr_b16 a[246:247], v92 offset:776
    ds_read_b64_tr_b16 a[248:249], v93 offset:0
    ds_read_b64_tr_b16 a[250:251], v93 offset:768
    ds_read_b64_tr_b16 a[252:253], v93 offset:8
    ds_read_b64_tr_b16 a[254:255], v93 offset:776
    ds_read_b64_tr_b16 v[224:225], v94 offset:0
    ds_read_b64_tr_b16 v[226:227], v94 offset:768
    ds_read_b64_tr_b16 v[228:229], v94 offset:8
    ds_read_b64_tr_b16 v[230:231], v94 offset:776
    v_mfma_f32_16x16x32_bf16 v[168:171], a[216:219], v[24:27], v[168:171]
    ds_read_b128 v[20:23], v32 offset:12800
    v_mfma_f32_16x16x32_bf16 v[172:175], a[220:223], v[24:27], v[172:175]
    s_add_u32 m0, s77, 0
    s_nop 0
    buffer_load_dwordx4 v2, s[72:75], s76 offen offset:2048 nt lds
    v_mfma_f32_16x16x32_bf16 v[176:179], a[224:227], v[24:27], v[176:179]
    v_mfma_f32_16x16x32_bf16 v[180:183], a[228:231], v[24:27], v[180:183]
    s_add_u32 m0, s77, 3072
    s_nop 0
    buffer_load_dwordx4 v3, s[72:75], s76 offen offset:0 nt lds
    v_mfma_f32_16x16x32_bf16 v[184:187], a[232:235], v[24:27], v[184:187]
    v_mfma_f32_16x16x32_bf16 v[188:191], a[236:239], v[24:27], v[188:191]
    s_waitcnt lgkmcnt(14)
    v_mfma_f32_16x16x32_bf16 v[192:195], a[216:219], v[28:31], v[192:195]
    ds_read_b128 v[24:27], v35 offset:512
    v_mfma_f32_16x16x32_bf16 v[196:199], a[220:223], v[28:31], v[196:199]
    s_add_u32 m0, s77, 3072
    s_nop 0
    buffer_load_dwordx4 v4, s[72:75], s76 offen offset:1024 nt lds
    v_mfma_f32_16x16x32_bf16 v[200:203], a[224:227], v[28:31], v[200:203]
    v_mfma_f32_16x16x32_bf16 v[204:207], a[228:231], v[28:31], v[204:207]
    s_add_u32 m0, s77, 3072
    s_nop 0
    buffer_load_dwordx4 v5, s[72:75], s76 offen offset:2048 nt lds
    v_mfma_f32_16x16x32_bf16 v[208:211], a[232:235], v[28:31], v[208:211]
    v_mfma_f32_16x16x32_bf16 v[212:215], a[236:239], v[28:31], v[212:215]
    s_waitcnt lgkmcnt(14)
    s_waitcnt lgkmcnt(2)
    s_waitcnt vmcnt(6)
    ds_read_b64_tr_b16 v[232:233], v92 offset:24576
    ds_read_b64_tr_b16 v[234:235], v92 offset:25344
    ds_read_b64_tr_b16 v[236:237], v92 offset:24584
    ds_read_b64_tr_b16 v[238:239], v92 offset:25352
    ds_read_b64_tr_b16 v[240:241], v93 offset:24576
    ds_read_b64_tr_b16 v[242:243], v93 offset:25344
    ds_read_b64_tr_b16 v[244:245], v93 offset:24584
    ds_read_b64_tr_b16 v[246:247], v93 offset:25352
    ds_read_b64_tr_b16 v[248:249], v94 offset:24576
    ds_read_b64_tr_b16 v[250:251], v94 offset:25344
    ds_read_b64_tr_b16 v[252:253], v94 offset:24584
    ds_read_b64_tr_b16 v[254:255], v94 offset:25352
    s_barrier
    v_mfma_f32_16x16x32_bf16 v[168:171], a[240:243], v[16:19], v[168:171]
    ds_read_b128 v[28:31], v33 offset:12800
    v_mfma_f32_16x16x32_bf16 v[172:175], a[244:247], v[16:19], v[172:175]
    v_mfma_f32_16x16x32_bf16 v[176:179], a[248:251], v[16:19], v[176:179]
    v_mfma_f32_16x16x32_bf16 v[180:183], a[252:255], v[16:19], v[180:183]
    v_mfma_f32_16x16x32_bf16 v[184:187], v[224:227], v[16:19], v[184:187]
    v_mfma_f32_16x16x32_bf16 v[188:191], v[228:231], v[16:19], v[188:191]
    s_waitcnt lgkmcnt(14)
    v_mfma_f32_16x16x32_bf16 v[192:195], a[240:243], v[20:23], v[192:195]
    ds_read_b128 v[16:19], v32 offset:24576
    v_mfma_f32_16x16x32_bf16 v[196:199], a[244:247], v[20:23], v[196:199]
    s_mov_b32 s72, s12
    s_mov_b32 s73, s13
    s_mov_b32 s74, s14
    s_add_u32 s76, s37, 15728640
    s_add_u32 s77, s36, 98304
    v_mfma_f32_16x16x32_bf16 v[200:203], a[248:251], v[20:23], v[200:203]
    s_add_u32 m0, s77, 0
    s_nop 0
    buffer_load_dwordx4 v0, s[72:75], s76 offen offset:0 nt lds
    v_mfma_f32_16x16x32_bf16 v[204:207], a[252:255], v[20:23], v[204:207]
    v_mfma_f32_16x16x32_bf16 v[208:211], v[224:227], v[20:23], v[208:211]
    s_add_u32 m0, s77, 0
    s_nop 0
    buffer_load_dwordx4 v1, s[72:75], s76 offen offset:1024 nt lds
    v_mfma_f32_16x16x32_bf16 v[212:215], v[228:231], v[20:23], v[212:215]
    s_waitcnt lgkmcnt(14)
    s_waitcnt lgkmcnt(2)
    v_mfma_f32_16x16x32_bf16 v[168:171], v[232:235], v[24:27], v[168:171]
    ds_read_b128 v[20:23], v33 offset:24576
    v_mfma_f32_16x16x32_bf16 v[172:175], v[236:239], v[24:27], v[172:175]
    s_add_u32 m0, s77, 0
    s_nop 0
    buffer_load_dwordx4 v2, s[72:75], s76 offen offset:2048 nt lds
    v_mfma_f32_16x16x32_bf16 v[176:179], v[240:243], v[24:27], v[176:179]
    v_mfma_f32_16x16x32_bf16 v[180:183], v[244:247], v[24:27], v[180:183]
    s_add_u32 m0, s77, 3072
    s_nop 0
    buffer_load_dwordx4 v3, s[72:75], s76 offen offset:0 nt lds
    v_mfma_f32_16x16x32_bf16 v[184:187], v[248:251], v[24:27], v[184:187]
    v_mfma_f32_16x16x32_bf16 v[188:191], v[252:255], v[24:27], v[188:191]
    s_waitcnt lgkmcnt(2)
    v_mfma_f32_16x16x32_bf16 v[192:195], v[232:235], v[28:31], v[192:195]
    ds_read_b128 v[24:27], v34 offset:24576
    v_mfma_f32_16x16x32_bf16 v[196:199], v[236:239], v[28:31], v[196:199]
    s_add_u32 m0, s77, 3072
    s_nop 0
    buffer_load_dwordx4 v4, s[72:75], s76 offen offset:1024 nt lds
    v_mfma_f32_16x16x32_bf16 v[200:203], v[240:243], v[28:31], v[200:203]
    v_mfma_f32_16x16x32_bf16 v[204:207], v[244:247], v[28:31], v[204:207]
    s_add_u32 m0, s77, 3072
    s_nop 0
    buffer_load_dwordx4 v5, s[72:75], s76 offen offset:2048 nt lds
    v_mfma_f32_16x16x32_bf16 v[208:211], v[248:251], v[28:31], v[208:211]
    v_mfma_f32_16x16x32_bf16 v[212:215], v[252:255], v[28:31], v[212:215]
    s_waitcnt lgkmcnt(2)
    v_mfma_f32_16x16x32_bf16 v[36:39], a[0:3], v[16:19], 0
    ds_read_b128 v[28:31], v35 offset:24576
    s_waitcnt lgkmcnt(2)
    v_mfma_f32_16x16x32_bf16 v[36:39], a[24:27], v[20:23], v[36:39]
    v_mfma_f32_16x16x32_bf16 v[40:43], a[4:7], v[16:19], 0
    v_mfma_f32_16x16x32_bf16 v[40:43], a[28:31], v[20:23], v[40:43]
    v_mfma_f32_16x16x32_bf16 v[44:47], a[8:11], v[16:19], 0
    v_mfma_f32_16x16x32_bf16 v[44:47], a[32:35], v[20:23], v[44:47]
    v_mfma_f32_16x16x32_bf16 v[48:51], a[12:15], v[16:19], 0
    v_mfma_f32_16x16x32_bf16 v[48:51], a[36:39], v[20:23], v[48:51]
    v_mfma_f32_16x16x32_bf16 v[52:55], a[16:19], v[16:19], 0
    v_mfma_f32_16x16x32_bf16 v[52:55], a[40:43], v[20:23], v[52:55]
    v_mfma_f32_16x16x32_bf16 v[56:59], a[20:23], v[16:19], 0
    v_mfma_f32_16x16x32_bf16 v[56:59], a[44:47], v[20:23], v[56:59]
    s_waitcnt lgkmcnt(1)
    v_mfma_f32_16x16x32_bf16 v[36:39], a[48:51], v[24:27], v[36:39]
    ds_read_b128 v[16:19], v32 offset:24832
    s_waitcnt lgkmcnt(1)
    v_mfma_f32_16x16x32_bf16 v[36:39], a[72:75], v[28:31], v[36:39]
    ds_read_b128 v[20:23], v33 offset:24832
    v_mfma_f32_16x16x32_bf16 v[40:43], a[52:55], v[24:27], v[40:43]
    v_cvt_pk_bf16_f32 v108, v168, v169
    v_cvt_pk_bf16_f32 v109, v170, v171
    v_mfma_f32_16x16x32_bf16 v[40:43], a[76:79], v[28:31], v[40:43]
    v_cvt_pk_bf16_f32 v110, v172, v173
    v_mfma_f32_16x16x32_bf16 v[44:47], a[56:59], v[24:27], v[44:47]
    v_cvt_pk_bf16_f32 v111, v174, v175
    v_mfma_f32_16x16x32_bf16 v[44:47], a[80:83], v[28:31], v[44:47]
    s_mov_b32 s72, s12
    s_mov_b32 s73, s13
    s_mov_b32 s74, s14
    s_add_u32 s76, s37, 22020096
    s_add_u32 s77, s36, 122880
    v_mfma_f32_16x16x32_bf16 v[48:51], a[60:63], v[24:27], v[48:51]
    s_add_u32 m0, s77, 0
    s_nop 0
    buffer_load_dwordx4 v0, s[72:75], s76 offen offset:0 nt lds
    v_mfma_f32_16x16x32_bf16 v[48:51], a[84:87], v[28:31], v[48:51]
    v_cvt_pk_bf16_f32 v112, v176, v177
    v_mfma_f32_16x16x32_bf16 v[52:55], a[64:67], v[24:27], v[52:55]
    v_cvt_pk_bf16_f32 v113, v178, v179
    v_mfma_f32_16x16x32_bf16 v[52:55], a[88:91], v[28:31], v[52:55]
    v_cvt_pk_bf16_f32 v114, v180, v181
    v_mfma_f32_16x16x32_bf16 v[56:59], a[68:71], v[24:27], v[56:59]
    v_cvt_pk_bf16_f32 v115, v182, v183
    v_mfma_f32_16x16x32_bf16 v[56:59], a[92:95], v[28:31], v[56:59]
    s_add_u32 m0, s77, 0
    s_nop 0
    buffer_load_dwordx4 v1, s[72:75], s76 offen offset:1024 nt lds
    s_waitcnt lgkmcnt(1)
    v_mfma_f32_16x16x32_bf16 v[36:39], a[96:99], v[16:19], v[36:39]
    ds_read_b128 v[24:27], v34 offset:24832
    s_waitcnt lgkmcnt(1)
    v_mfma_f32_16x16x32_bf16 v[36:39], a[120:123], v[20:23], v[36:39]
    ds_read_b128 v[28:31], v35 offset:24832
    v_mfma_f32_16x16x32_bf16 v[40:43], a[100:103], v[16:19], v[40:43]
    v_cvt_pk_bf16_f32 v116, v184, v185
    v_mfma_f32_16x16x32_bf16 v[40:43], a[124:127], v[20:23], v[40:43]
    v_cvt_pk_bf16_f32 v117, v186, v187
    v_mfma_f32_16x16x32_bf16 v[44:47], a[104:107], v[16:19], v[44:47]
    v_cvt_pk_bf16_f32 v118, v188, v189
    v_mfma_f32_16x16x32_bf16 v[44:47], a[128:131], v[20:23], v[44:47]
    v_cvt_pk_bf16_f32 v119, v190, v191
    v_mfma_f32_16x16x32_bf16 v[48:51], a[108:111], v[16:19], v[48:51]
    s_add_u32 m0, s77, 0
    s_nop 0
    buffer_load_dwordx4 v2, s[72:75], s76 offen offset:2048 nt lds
    v_mfma_f32_16x16x32_bf16 v[48:51], a[132:135], v[20:23], v[48:51]
    v_cvt_pk_bf16_f32 v120, v192, v193
    v_mfma_f32_16x16x32_bf16 v[52:55], a[112:115], v[16:19], v[52:55]
    v_cvt_pk_bf16_f32 v121, v194, v195
    v_mfma_f32_16x16x32_bf16 v[52:55], a[136:139], v[20:23], v[52:55]
    v_cvt_pk_bf16_f32 v122, v196, v197
    v_mfma_f32_16x16x32_bf16 v[56:59], a[116:119], v[16:19], v[56:59]
    v_cvt_pk_bf16_f32 v123, v198, v199
    v_mfma_f32_16x16x32_bf16 v[56:59], a[140:143], v[20:23], v[56:59]
    s_add_u32 m0, s77, 3072
    s_nop 0
    buffer_load_dwordx4 v3, s[72:75], s76 offen offset:0 nt lds
    s_waitcnt lgkmcnt(1)
    v_mfma_f32_16x16x32_bf16 v[36:39], a[144:147], v[24:27], v[36:39]
    ds_read_b128 v[16:19], v32 offset:25088
    s_waitcnt lgkmcnt(1)
    v_mfma_f32_16x16x32_bf16 v[36:39], a[168:171], v[28:31], v[36:39]
    ds_read_b128 v[20:23], v33 offset:25088
    v_mfma_f32_16x16x32_bf16 v[40:43], a[148:151], v[24:27], v[40:43]
    v_cvt_pk_bf16_f32 v124, v200, v201
    v_mfma_f32_16x16x32_bf16 v[40:43], a[172:175], v[28:31], v[40:43]
    v_cvt_pk_bf16_f32 v125, v202, v203
    v_mfma_f32_16x16x32_bf16 v[44:47], a[152:155], v[24:27], v[44:47]
    v_cvt_pk_bf16_f32 v126, v204, v205
    v_mfma_f32_16x16x32_bf16 v[44:47], a[176:179], v[28:31], v[44:47]
    v_cvt_pk_bf16_f32 v127, v206, v207
    v_mfma_f32_16x16x32_bf16 v[48:51], a[156:159], v[24:27], v[48:51]
    s_add_u32 m0, s77, 3072
    s_nop 0
    buffer_load_dwordx4 v4, s[72:75], s76 offen offset:1024 nt lds
    v_mfma_f32_16x16x32_bf16 v[48:51], a[180:183], v[28:31], v[48:51]
    v_cvt_pk_bf16_f32 v128, v208, v209
    v_mfma_f32_16x16x32_bf16 v[52:55], a[160:163], v[24:27], v[52:55]
    v_cvt_pk_bf16_f32 v129, v210, v211
    v_mfma_f32_16x16x32_bf16 v[52:55], a[184:187], v[28:31], v[52:55]
    v_cvt_pk_bf16_f32 v130, v212, v213
    v_mfma_f32_16x16x32_bf16 v[56:59], a[164:167], v[24:27], v[56:59]
    v_cvt_pk_bf16_f32 v131, v214, v215
    v_mfma_f32_16x16x32_bf16 v[56:59], a[188:191], v[28:31], v[56:59]
    s_add_u32 m0, s77, 3072
    s_nop 0
    buffer_load_dwordx4 v5, s[72:75], s76 offen offset:2048 nt lds
    s_waitcnt lgkmcnt(1)
    v_mfma_f32_16x16x32_bf16 v[36:39], a[192:195], v[16:19], v[36:39]
    ds_read_b128 v[24:27], v34 offset:25088
    s_waitcnt lgkmcnt(1)
    v_mfma_f32_16x16x32_bf16 v[36:39], a[216:219], v[20:23], v[36:39]
    ds_read_b128 v[28:31], v35 offset:25088
    v_mfma_f32_16x16x32_bf16 v[40:43], a[196:199], v[16:19], v[40:43]
    v_mfma_f32_16x16x32_bf16 v[40:43], a[220:223], v[20:23], v[40:43]
    v_mfma_f32_16x16x32_bf16 v[44:47], a[200:203], v[16:19], v[44:47]
    v_mfma_f32_16x16x32_bf16 v[44:47], a[224:227], v[20:23], v[44:47]
    v_mfma_f32_16x16x32_bf16 v[48:51], a[204:207], v[16:19], v[48:51]
    v_mfma_f32_16x16x32_bf16 v[48:51], a[228:231], v[20:23], v[48:51]
    v_mfma_f32_16x16x32_bf16 v[52:55], a[208:211], v[16:19], v[52:55]
    v_mfma_f32_16x16x32_bf16 v[52:55], a[232:235], v[20:23], v[52:55]
    v_mfma_f32_16x16x32_bf16 v[56:59], a[212:215], v[16:19], v[56:59]
    v_mfma_f32_16x16x32_bf16 v[56:59], a[236:239], v[20:23], v[56:59]
    s_waitcnt lgkmcnt(1)
    v_mfma_f32_16x16x32_bf16 v[36:39], a[240:243], v[24:27], v[36:39]
    ds_read_b128 v[16:19], v34 offset:36864
    s_waitcnt lgkmcnt(1)
    v_mfma_f32_16x16x32_bf16 v[36:39], v[232:235], v[28:31], v[36:39]
    ds_read_b128 v[20:23], v35 offset:36864
    v_mfma_f32_16x16x32_bf16 v[40:43], a[244:247], v[24:27], v[40:43]
    s_mov_b32 s72, s8
    s_mov_b32 s73, s9
    s_mov_b32 s74, s10
    s_mov_b32 s76, s41
    s_add_u32 s77, s36, 0
    v_mfma_f32_16x16x32_bf16 v[40:43], v[236:239], v[28:31], v[40:43]
    v_mfma_f32_16x16x32_bf16 v[44:47], a[248:251], v[24:27], v[44:47]
    v_mfma_f32_16x16x32_bf16 v[44:47], v[240:243], v[28:31], v[44:47]
    s_add_u32 m0, s77, 0
    s_nop 0
    buffer_load_dwordx4 v0, s[72:75], s76 offen offset:0 nt lds
    v_mfma_f32_16x16x32_bf16 v[48:51], a[252:255], v[24:27], v[48:51]
    v_mfma_f32_16x16x32_bf16 v[48:51], v[244:247], v[28:31], v[48:51]
    v_mfma_f32_16x16x32_bf16 v[52:55], v[224:227], v[24:27], v[52:55]
    s_add_u32 m0, s77, 0
    s_nop 0
    buffer_load_dwordx4 v1, s[72:75], s76 offen offset:1024 nt lds
    v_mfma_f32_16x16x32_bf16 v[52:55], v[248:251], v[28:31], v[52:55]
    v_mfma_f32_16x16x32_bf16 v[56:59], v[228:231], v[24:27], v[56:59]
    v_mfma_f32_16x16x32_bf16 v[56:59], v[252:255], v[28:31], v[56:59]
    s_waitcnt lgkmcnt(1)
    v_mfma_f32_16x16x32_bf16 v[60:63], a[0:3], v[16:19], 0
    ds_read_b128 v[24:27], v32 offset:36864
    s_waitcnt lgkmcnt(1)
    v_mfma_f32_16x16x32_bf16 v[60:63], a[24:27], v[20:23], v[60:63]
    ds_read_b128 v[28:31], v33 offset:36864
    v_mfma_f32_16x16x32_bf16 v[64:67], a[4:7], v[16:19], 0
    s_add_u32 m0, s77, 0
    s_nop 0
    buffer_load_dwordx4 v2, s[72:75], s76 offen offset:2048 nt lds
    v_mfma_f32_16x16x32_bf16 v[64:67], a[28:31], v[20:23], v[64:67]
    v_mfma_f32_16x16x32_bf16 v[68:71], a[8:11], v[16:19], 0
    v_mfma_f32_16x16x32_bf16 v[68:71], a[32:35], v[20:23], v[68:71]
    v_mfma_f32_16x16x32_bf16 v[72:75], a[12:15], v[16:19], 0
    v_mfma_f32_16x16x32_bf16 v[72:75], a[36:39], v[20:23], v[72:75]
    s_add_u32 m0, s77, 3072
    s_nop 0
    buffer_load_dwordx4 v3, s[72:75], s76 offen offset:0 nt lds
    v_mfma_f32_16x16x32_bf16 v[76:79], a[16:19], v[16:19], 0
    v_mfma_f32_16x16x32_bf16 v[76:79], a[40:43], v[20:23], v[76:79]
    v_mfma_f32_16x16x32_bf16 v[80:83], a[20:23], v[16:19], 0
    v_mfma_f32_16x16x32_bf16 v[80:83], a[44:47], v[20:23], v[80:83]
    s_waitcnt lgkmcnt(1)
    v_mfma_f32_16x16x32_bf16 v[60:63], a[48:51], v[24:27], v[60:63]
    ds_read_b128 v[16:19], v34 offset:37120
    s_waitcnt lgkmcnt(1)
    v_mfma_f32_16x16x32_bf16 v[60:63], a[72:75], v[28:31], v[60:63]
    ds_read_b128 v[20:23], v35 offset:37120
    v_mfma_f32_16x16x32_bf16 v[64:67], a[52:55], v[24:27], v[64:67]
    v_cvt_pk_bf16_f32 v132, v36, v37
    v_mfma_f32_16x16x32_bf16 v[64:67], a[76:79], v[28:31], v[64:67]
    v_cvt_pk_bf16_f32 v133, v38, v39
    v_mfma_f32_16x16x32_bf16 v[68:71], a[56:59], v[24:27], v[68:71]
    v_cvt_pk_bf16_f32 v134, v40, v41
    v_mfma_f32_16x16x32_bf16 v[68:71], a[80:83], v[28:31], v[68:71]
    v_cvt_pk_bf16_f32 v135, v42, v43
    v_mfma_f32_16x16x32_bf16 v[72:75], a[60:63], v[24:27], v[72:75]
    s_add_u32 m0, s77, 3072
    s_nop 0
    buffer_load_dwordx4 v4, s[72:75], s76 offen offset:1024 nt lds
    v_mfma_f32_16x16x32_bf16 v[72:75], a[84:87], v[28:31], v[72:75]
    v_cvt_pk_bf16_f32 v136, v44, v45
    v_mfma_f32_16x16x32_bf16 v[76:79], a[64:67], v[24:27], v[76:79]
    v_cvt_pk_bf16_f32 v137, v46, v47
    v_mfma_f32_16x16x32_bf16 v[76:79], a[88:91], v[28:31], v[76:79]
    v_cvt_pk_bf16_f32 v138, v48, v49
    v_mfma_f32_16x16x32_bf16 v[80:83], a[68:71], v[24:27], v[80:83]
    v_cvt_pk_bf16_f32 v139, v50, v51
    v_mfma_f32_16x16x32_bf16 v[80:83], a[92:95], v[28:31], v[80:83]
    s_add_u32 m0, s77, 3072
    s_nop 0
    buffer_load_dwordx4 v5, s[72:75], s76 offen offset:2048 nt lds
    s_waitcnt lgkmcnt(1)
    v_mfma_f32_16x16x32_bf16 v[60:63], a[96:99], v[16:19], v[60:63]
    ds_read_b128 v[24:27], v32 offset:37120
    s_waitcnt lgkmcnt(1)
    v_mfma_f32_16x16x32_bf16 v[60:63], a[120:123], v[20:23], v[60:63]
    ds_read_b128 v[28:31], v33 offset:37120
    v_mfma_f32_16x16x32_bf16 v[64:67], a[100:103], v[16:19], v[64:67]
    v_cvt_pk_bf16_f32 v140, v52, v53
    v_mfma_f32_16x16x32_bf16 v[64:67], a[124:127], v[20:23], v[64:67]
    v_mfma_f32_16x16x32_bf16 v[68:71], a[104:107], v[16:19], v[68:71]
    v_cvt_pk_bf16_f32 v141, v54, v55
    v_mfma_f32_16x16x32_bf16 v[68:71], a[128:131], v[20:23], v[68:71]
    v_mfma_f32_16x16x32_bf16 v[72:75], a[108:111], v[16:19], v[72:75]
    v_mfma_f32_16x16x32_bf16 v[72:75], a[132:135], v[20:23], v[72:75]
    v_cvt_pk_bf16_f32 v142, v56, v57
    v_mfma_f32_16x16x32_bf16 v[76:79], a[112:115], v[16:19], v[76:79]
    v_mfma_f32_16x16x32_bf16 v[76:79], a[136:139], v[20:23], v[76:79]
    v_cvt_pk_bf16_f32 v143, v58, v59
    v_mfma_f32_16x16x32_bf16 v[80:83], a[116:119], v[16:19], v[80:83]
    v_mfma_f32_16x16x32_bf16 v[80:83], a[140:143], v[20:23], v[80:83]
    s_waitcnt lgkmcnt(1)
    v_mfma_f32_16x16x32_bf16 v[60:63], a[144:147], v[24:27], v[60:63]
    ds_read_b128 v[16:19], v34 offset:37376
    s_waitcnt lgkmcnt(1)
    v_mfma_f32_16x16x32_bf16 v[60:63], a[168:171], v[28:31], v[60:63]
    ds_read_b128 v[20:23], v35 offset:37376
    v_mfma_f32_16x16x32_bf16 v[64:67], a[148:151], v[24:27], v[64:67]
    buffer_load_dword v220, v222, s[32:35], 0 offen sc1
    v_mfma_f32_16x16x32_bf16 v[64:67], a[172:175], v[28:31], v[64:67]
    v_mfma_f32_16x16x32_bf16 v[68:71], a[152:155], v[24:27], v[68:71]
    v_mfma_f32_16x16x32_bf16 v[68:71], a[176:179], v[28:31], v[68:71]
    v_mfma_f32_16x16x32_bf16 v[72:75], a[156:159], v[24:27], v[72:75]
    v_mfma_f32_16x16x32_bf16 v[72:75], a[180:183], v[28:31], v[72:75]
    v_mfma_f32_16x16x32_bf16 v[76:79], a[160:163], v[24:27], v[76:79]
    v_mfma_f32_16x16x32_bf16 v[76:79], a[184:187], v[28:31], v[76:79]
    v_mfma_f32_16x16x32_bf16 v[80:83], a[164:167], v[24:27], v[80:83]
    v_mfma_f32_16x16x32_bf16 v[80:83], a[188:191], v[28:31], v[80:83]
    s_waitcnt lgkmcnt(1)
    s_waitcnt vmcnt(19)
    s_barrier
    v_mfma_f32_16x16x32_bf16 v[60:63], a[192:195], v[16:19], v[60:63]
    ds_read_b128 v[24:27], v32 offset:37376
    s_waitcnt lgkmcnt(1)
    v_mfma_f32_16x16x32_bf16 v[60:63], a[216:219], v[20:23], v[60:63]
    ds_read_b128 v[28:31], v33 offset:37376
    v_mfma_f32_16x16x32_bf16 v[64:67], a[196:199], v[16:19], v[64:67]
    s_mov_b32 s72, s8
    s_mov_b32 s73, s9
    s_mov_b32 s74, s10
    s_mov_b32 s76, s42
    s_add_u32 s77, s36, 24576
    v_mfma_f32_16x16x32_bf16 v[64:67], a[220:223], v[20:23], v[64:67]
    v_mfma_f32_16x16x32_bf16 v[68:71], a[200:203], v[16:19], v[68:71]
    v_mfma_f32_16x16x32_bf16 v[68:71], a[224:227], v[20:23], v[68:71]
    v_mfma_f32_16x16x32_bf16 v[72:75], a[204:207], v[16:19], v[72:75]
    v_mfma_f32_16x16x32_bf16 v[72:75], a[228:231], v[20:23], v[72:75]
    s_add_u32 m0, s77, 0
    s_nop 0
    buffer_load_dwordx4 v0, s[72:75], s76 offen offset:0 nt lds
    v_mfma_f32_16x16x32_bf16 v[76:79], a[208:211], v[16:19], v[76:79]
    v_mfma_f32_16x16x32_bf16 v[76:79], a[232:235], v[20:23], v[76:79]
    v_mfma_f32_16x16x32_bf16 v[80:83], a[212:215], v[16:19], v[80:83]
    v_mfma_f32_16x16x32_bf16 v[80:83], a[236:239], v[20:23], v[80:83]
    s_waitcnt lgkmcnt(1)
    v_mfma_f32_16x16x32_bf16 v[60:63], a[240:243], v[24:27], v[60:63]
    ds_read_b128 v[16:19], v216 offset:49152
    s_waitcnt lgkmcnt(1)
    v_mfma_f32_16x16x32_bf16 v[60:63], v[232:235], v[28:31], v[60:63]
    ds_read_b128 v[20:23], v217 offset:49152
    v_mfma_f32_16x16x32_bf16 v[64:67], a[244:247], v[24:27], v[64:67]
    s_add_u32 m0, s77, 0
    s_nop 0
    buffer_load_dwordx4 v1, s[72:75], s76 offen offset:1024 nt lds
    v_mfma_f32_16x16x32_bf16 v[64:67], v[236:239], v[28:31], v[64:67]
    v_mfma_f32_16x16x32_bf16 v[68:71], a[248:251], v[24:27], v[68:71]
    v_mfma_f32_16x16x32_bf16 v[68:71], v[240:243], v[28:31], v[68:71]
    v_mfma_f32_16x16x32_bf16 v[72:75], a[252:255], v[24:27], v[72:75]
    v_mfma_f32_16x16x32_bf16 v[72:75], v[244:247], v[28:31], v[72:75]
    s_add_u32 m0, s77, 0
    s_nop 0
    buffer_load_dwordx4 v2, s[72:75], s76 offen offset:2048 nt lds
    v_mfma_f32_16x16x32_bf16 v[76:79], v[224:227], v[24:27], v[76:79]
    v_mfma_f32_16x16x32_bf16 v[76:79], v[248:251], v[28:31], v[76:79]
    v_mfma_f32_16x16x32_bf16 v[80:83], v[228:231], v[24:27], v[80:83]
    v_mfma_f32_16x16x32_bf16 v[80:83], v[252:255], v[28:31], v[80:83]
    s_waitcnt lgkmcnt(1)
    v_mfma_f32_16x16x32_bf16 v[36:39], a[0:3], v[16:19], 0
    ds_read_b128 v[24:27], v218 offset:49152
    s_waitcnt lgkmcnt(1)
    v_mfma_f32_16x16x32_bf16 v[36:39], a[24:27], v[20:23], v[36:39]
    ds_read_b128 v[28:31], v219 offset:49152
    v_mfma_f32_16x16x32_bf16 v[40:43], a[4:7], v[16:19], 0
    s_add_u32 m0, s77, 3072
    s_nop 0
    buffer_load_dwordx4 v3, s[72:75], s76 offen offset:0 nt lds
    v_mfma_f32_16x16x32_bf16 v[40:43], a[28:31], v[20:23], v[40:43]
    v_mfma_f32_16x16x32_bf16 v[44:47], a[8:11], v[16:19], 0
    v_mfma_f32_16x16x32_bf16 v[44:47], a[32:35], v[20:23], v[44:47]
    v_mfma_f32_16x16x32_bf16 v[48:51], a[12:15], v[16:19], 0
    v_mfma_f32_16x16x32_bf16 v[48:51], a[36:39], v[20:23], v[48:51]
    s_add_u32 m0, s77, 3072
    s_nop 0
    buffer_load_dwordx4 v4, s[72:75], s76 offen offset:1024 nt lds
    v_mfma_f32_16x16x32_bf16 v[52:55], a[16:19], v[16:19], 0
    v_mfma_f32_16x16x32_bf16 v[52:55], a[40:43], v[20:23], v[52:55]
    v_mfma_f32_16x16x32_bf16 v[56:59], a[20:23], v[16:19], 0
    v_mfma_f32_16x16x32_bf16 v[56:59], a[44:47], v[20:23], v[56:59]
    s_waitcnt lgkmcnt(1)
    v_mfma_f32_16x16x32_bf16 v[36:39], a[48:51], v[24:27], v[36:39]
    ds_read_b128 v[16:19], v216 offset:49408
    s_waitcnt lgkmcnt(1)
    v_mfma_f32_16x16x32_bf16 v[36:39], a[72:75], v[28:31], v[36:39]
    ds_read_b128 v[20:23], v217 offset:49408
    v_mfma_f32_16x16x32_bf16 v[40:43], a[52:55], v[24:27], v[40:43]
    v_cvt_pk_bf16_f32 v144, v60, v61
    v_mfma_f32_16x16x32_bf16 v[40:43], a[76:79], v[28:31], v[40:43]
    v_cvt_pk_bf16_f32 v145, v62, v63
    v_mfma_f32_16x16x32_bf16 v[44:47], a[56:59], v[24:27], v[44:47]
    v_cvt_pk_bf16_f32 v146, v64, v65
    v_mfma_f32_16x16x32_bf16 v[44:47], a[80:83], v[28:31], v[44:47]
    v_cvt_pk_bf16_f32 v147, v66, v67
    v_mfma_f32_16x16x32_bf16 v[48:51], a[60:63], v[24:27], v[48:51]
    s_add_u32 m0, s77, 3072
    s_nop 0
    buffer_load_dwordx4 v5, s[72:75], s76 offen offset:2048 nt lds
    v_mfma_f32_16x16x32_bf16 v[48:51], a[84:87], v[28:31], v[48:51]
    v_cvt_pk_bf16_f32 v148, v68, v69
    v_mfma_f32_16x16x32_bf16 v[52:55], a[64:67], v[24:27], v[52:55]
    v_cvt_pk_bf16_f32 v149, v70, v71
    v_mfma_f32_16x16x32_bf16 v[52:55], a[88:91], v[28:31], v[52:55]
    v_cvt_pk_bf16_f32 v150, v72, v73
    v_mfma_f32_16x16x32_bf16 v[56:59], a[68:71], v[24:27], v[56:59]
    v_cvt_pk_bf16_f32 v151, v74, v75
    v_mfma_f32_16x16x32_bf16 v[56:59], a[92:95], v[28:31], v[56:59]
    s_waitcnt lgkmcnt(1)
    v_mfma_f32_16x16x32_bf16 v[36:39], a[96:99], v[16:19], v[36:39]
    ds_read_b128 v[24:27], v218 offset:49408
    s_waitcnt lgkmcnt(1)
    v_mfma_f32_16x16x32_bf16 v[36:39], a[120:123], v[20:23], v[36:39]
    ds_read_b128 v[28:31], v219 offset:49408
    v_mfma_f32_16x16x32_bf16 v[40:43], a[100:103], v[16:19], v[40:43]
    v_cvt_pk_bf16_f32 v152, v76, v77
    v_mfma_f32_16x16x32_bf16 v[40:43], a[124:127], v[20:23], v[40:43]
    v_mfma_f32_16x16x32_bf16 v[44:47], a[104:107], v[16:19], v[44:47]
    v_cvt_pk_bf16_f32 v153, v78, v79
    v_mfma_f32_16x16x32_bf16 v[44:47], a[128:131], v[20:23], v[44:47]
    v_mfma_f32_16x16x32_bf16 v[48:51], a[108:111], v[16:19], v[48:51]
    v_mfma_f32_16x16x32_bf16 v[48:51], a[132:135], v[20:23], v[48:51]
    v_cvt_pk_bf16_f32 v154, v80, v81
    v_mfma_f32_16x16x32_bf16 v[52:55], a[112:115], v[16:19], v[52:55]
    v_mfma_f32_16x16x32_bf16 v[52:55], a[136:139], v[20:23], v[52:55]
    v_cvt_pk_bf16_f32 v155, v82, v83
    v_mfma_f32_16x16x32_bf16 v[56:59], a[116:119], v[16:19], v[56:59]
    v_mfma_f32_16x16x32_bf16 v[56:59], a[140:143], v[20:23], v[56:59]
    s_waitcnt lgkmcnt(1)
    v_mfma_f32_16x16x32_bf16 v[36:39], a[144:147], v[24:27], v[36:39]
    ds_read_b128 v[16:19], v216 offset:49664
    s_waitcnt lgkmcnt(1)
    v_mfma_f32_16x16x32_bf16 v[36:39], a[168:171], v[28:31], v[36:39]
    ds_read_b128 v[20:23], v217 offset:49664
    v_mfma_f32_16x16x32_bf16 v[40:43], a[148:151], v[24:27], v[40:43]
    v_mfma_f32_16x16x32_bf16 v[40:43], a[172:175], v[28:31], v[40:43]
    v_mfma_f32_16x16x32_bf16 v[44:47], a[152:155], v[24:27], v[44:47]
    v_mfma_f32_16x16x32_bf16 v[44:47], a[176:179], v[28:31], v[44:47]
    v_mfma_f32_16x16x32_bf16 v[48:51], a[156:159], v[24:27], v[48:51]
    v_mfma_f32_16x16x32_bf16 v[48:51], a[180:183], v[28:31], v[48:51]
    v_mfma_f32_16x16x32_bf16 v[52:55], a[160:163], v[24:27], v[52:55]
    v_mfma_f32_16x16x32_bf16 v[52:55], a[184:187], v[28:31], v[52:55]
    v_mfma_f32_16x16x32_bf16 v[56:59], a[164:167], v[24:27], v[56:59]
    v_mfma_f32_16x16x32_bf16 v[56:59], a[188:191], v[28:31], v[56:59]
    s_waitcnt lgkmcnt(1)
    s_waitcnt vmcnt(6)
    s_mov_b32 s63, 0
    s_cmp_lg_u32 s3, 0
    s_cbranch_scc1 L_spun
L_spin:
    v_readfirstlane_b32 s38, v220
    s_cmp_ge_u32 s38, 72
    s_cbranch_scc1 L_spun
    s_add_u32 s63, s63, 1
    s_cmp_gt_u32 s63, 0x40000
    s_cbranch_scc1 L_spun
    s_sleep 16
    buffer_load_dword v220, v222, s[32:35], 0 offen sc1
    s_waitcnt vmcnt(0)
    s_branch L_spin
L_spun:
    s_barrier
    v_mfma_f32_16x16x32_bf16 v[36:39], a[192:195], v[16:19], v[36:39]
    ds_read_b128 v[24:27], v218 offset:49664
    s_waitcnt lgkmcnt(1)
    v_mfma_f32_16x16x32_bf16 v[36:39], a[216:219], v[20:23], v[36:39]
    ds_read_b128 v[28:31], v219 offset:49664
    v_mfma_f32_16x16x32_bf16 v[40:43], a[196:199], v[16:19], v[40:43]
    s_cmp_ge_u32 s93, 24
    s_mul_i32 s38, s93, 3072
    s_cselect_b32 s38, 0x80000000, s38
    s_lshl_b32 s39, s3, 10
    s_add_u32 m0, s39, 159744
    s_nop 0
    buffer_load_dwordx4 v15, s[16:19], s38 offen sc1 lds
    s_add_u32 s38, s38, 1024
    buffer_load_dwordx4 v15, s[16:19], s38 offen sc1 lds
    s_add_u32 s38, s38, 1024
    buffer_load_dwordx4 v15, s[16:19], s38 offen sc1 lds
    v_mfma_f32_16x16x32_bf16 v[40:43], a[220:223], v[20:23], v[40:43]
    v_mfma_f32_16x16x32_bf16 v[44:47], a[200:203], v[16:19], v[44:47]
    v_mfma_f32_16x16x32_bf16 v[44:47], a[224:227], v[20:23], v[44:47]
    v_mfma_f32_16x16x32_bf16 v[48:51], a[204:207], v[16:19], v[48:51]
    v_mfma_f32_16x16x32_bf16 v[48:51], a[228:231], v[20:23], v[48:51]
    v_mfma_f32_16x16x32_bf16 v[52:55], a[208:211], v[16:19], v[52:55]
    v_mfma_f32_16x16x32_bf16 v[52:55], a[232:235], v[20:23], v[52:55]
    v_mfma_f32_16x16x32_bf16 v[56:59], a[212:215], v[16:19], v[56:59]
    v_mfma_f32_16x16x32_bf16 v[56:59], a[236:239], v[20:23], v[56:59]
    s_waitcnt lgkmcnt(1)
    v_mfma_f32_16x16x32_bf16 v[36:39], a[240:243], v[24:27], v[36:39]
    ds_read_b128 v[16:19], v216 offset:0
    s_waitcnt lgkmcnt(1)
    v_mfma_f32_16x16x32_bf16 v[36:39], v[232:235], v[28:31], v[36:39]
    ds_read_b128 v[20:23], v218 offset:12288
    v_mfma_f32_16x16x32_bf16 v[40:43], a[244:247], v[24:27], v[40:43]
    v_mfma_f32_16x16x32_bf16 v[40:43], v[236:239], v[28:31], v[40:43]
    v_mfma_f32_16x16x32_bf16 v[44:47], a[248:251], v[24:27], v[44:47]
    v_mfma_f32_16x16x32_bf16 v[44:47], v[240:243], v[28:31], v[44:47]
    v_mfma_f32_16x16x32_bf16 v[48:51], a[252:255], v[24:27], v[48:51]
    v_mfma_f32_16x16x32_bf16 v[48:51], v[244:247], v[28:31], v[48:51]
    v_mfma_f32_16x16x32_bf16 v[52:55], v[224:227], v[24:27], v[52:55]
    v_mfma_f32_16x16x32_bf16 v[52:55], v[248:251], v[28:31], v[52:55]
    v_mfma_f32_16x16x32_bf16 v[56:59], v[228:231], v[24:27], v[56:59]
    v_mfma_f32_16x16x32_bf16 v[56:59], v[252:255], v[28:31], v[56:59]
    s_waitcnt lgkmcnt(1)
    v_mfma_f32_16x16x32_bf16 v[168:171], a[0:3], v[16:19], 0
    ds_read_b128 v[24:27], v216 offset:24576
    v_mfma_f32_16x16x32_bf16 v[172:175], a[4:7], v[16:19], 0
    v_mfma_f32_16x16x32_bf16 v[176:179], a[8:11], v[16:19], 0
    v_mfma_f32_16x16x32_bf16 v[180:183], a[12:15], v[16:19], 0
    v_mfma_f32_16x16x32_bf16 v[184:187], a[16:19], v[16:19], 0
    v_mfma_f32_16x16x32_bf16 v[188:191], a[20:23], v[16:19], 0
    s_waitcnt lgkmcnt(1)
    v_mfma_f32_16x16x32_bf16 v[192:195], a[0:3], v[20:23], 0
    ds_read_b128 v[28:31], v218 offset:36864
    v_mfma_f32_16x16x32_bf16 v[196:199], a[4:7], v[20:23], 0
    v_mfma_f32_16x16x32_bf16 v[200:203], a[8:11], v[20:23], 0
    v_mfma_f32_16x16x32_bf16 v[204:207], a[12:15], v[20:23], 0
    v_mfma_f32_16x16x32_bf16 v[208:211], a[16:19], v[20:23], 0
    v_mfma_f32_16x16x32_bf16 v[212:215], a[20:23], v[20:23], 0
    s_waitcnt lgkmcnt(1)
    v_mfma_f32_16x16x32_bf16 v[60:63], a[0:3], v[24:27], 0
    ds_read_b128 v[16:19], v217 offset:0
    v_mfma_f32_16x16x32_bf16 v[64:67], a[4:7], v[24:27], 0
    v_cvt_pk_bf16_f32 v156, v36, v37
    v_mfma_f32_16x16x32_bf16 v[68:71], a[8:11], v[24:27], 0
    v_cvt_pk_bf16_f32 v157, v38, v39
    v_mfma_f32_16x16x32_bf16 v[72:75], a[12:15], v[24:27], 0
    v_cvt_pk_bf16_f32 v158, v40, v41
    v_mfma_f32_16x16x32_bf16 v[76:79], a[16:19], v[24:27], 0
    v_cvt_pk_bf16_f32 v159, v42, v43
    v_mfma_f32_16x16x32_bf16 v[80:83], a[20:23], v[24:27], 0
    s_waitcnt lgkmcnt(1)
    v_mfma_f32_16x16x32_bf16 v[84:87], a[0:3], v[28:31], 0
    ds_read_b128 v[20:23], v219 offset:12288
    v_mfma_f32_16x16x32_bf16 v[88:91], a[4:7], v[28:31], 0
    v_cvt_pk_bf16_f32 v160, v44, v45
    v_mfma_f32_16x16x32_bf16 v[92:95], a[8:11], v[28:31], 0
    v_cvt_pk_bf16_f32 v161, v46, v47
    v_mfma_f32_16x16x32_bf16 v[96:99], a[12:15], v[28:31], 0
    v_cvt_pk_bf16_f32 v162, v48, v49
    v_mfma_f32_16x16x32_bf16 v[100:103], a[16:19], v[28:31], 0
    v_cvt_pk_bf16_f32 v163, v50, v51
    v_mfma_f32_16x16x32_bf16 v[104:107], a[20:23], v[28:31], 0
    s_waitcnt lgkmcnt(1)
    v_mfma_f32_16x16x32_bf16 v[168:171], a[24:27], v[16:19], v[168:171]
    ds_read_b128 v[24:27], v217 offset:24576
    v_mfma_f32_16x16x32_bf16 v[172:175], a[28:31], v[16:19], v[172:175]
    v_cvt_pk_bf16_f32 v164, v52, v53
    v_cvt_pk_bf16_f32 v165, v54, v55
    v_mfma_f32_16x16x32_bf16 v[176:179], a[32:35], v[16:19], v[176:179]
    v_cvt_pk_bf16_f32 v166, v56, v57
    v_mfma_f32_16x16x32_bf16 v[180:183], a[36:39], v[16:19], v[180:183]
    v_cvt_pk_bf16_f32 v167, v58, v59
    v_mfma_f32_16x16x32_bf16 v[184:187], a[40:43], v[16:19], v[184:187]
    s_mov_b32 s61, 0
    buffer_load_dwordx4 a[0:3], v15, s[16:19], s61 offen offset:0 sc1
    v_mfma_f32_16x16x32_bf16 v[188:191], a[44:47], v[16:19], v[188:191]
    buffer_load_dwordx4 a[4:7], v15, s[16:19], s61 offen offset:1024 sc1
    s_waitcnt lgkmcnt(1)
    v_mfma_f32_16x16x32_bf16 v[192:195], a[24:27], v[20:23], v[192:195]
    ds_read_b128 v[28:31], v219 offset:36864
    v_mfma_f32_16x16x32_bf16 v[196:199], a[28:31], v[20:23], v[196:199]
    buffer_load_dwordx4 a[8:11], v15, s[16:19], s61 offen offset:2048 sc1
    v_mfma_f32_16x16x32_bf16 v[200:203], a[32:35], v[20:23], v[200:203]
    v_mfma_f32_16x16x32_bf16 v[204:207], a[36:39], v[20:23], v[204:207]
    v_mfma_f32_16x16x32_bf16 v[208:211], a[40:43], v[20:23], v[208:211]
    v_mfma_f32_16x16x32_bf16 v[212:215], a[44:47], v[20:23], v[212:215]
    s_waitcnt lgkmcnt(1)
    v_mfma_f32_16x16x32_bf16 v[60:63], a[24:27], v[24:27], v[60:63]
    ds_read_b128 v[16:19], v218 offset:0
    v_mfma_f32_16x16x32_bf16 v[64:67], a[28:31], v[24:27], v[64:67]
    buffer_load_dwordx4 a[12:15], v15, s[16:19], s61 offen offset:3072 sc1
    v_mfma_f32_16x16x32_bf16 v[68:71], a[32:35], v[24:27], v[68:71]
    v_mfma_f32_16x16x32_bf16 v[72:75], a[36:39], v[24:27], v[72:75]
    s_mov_b32 s61, 4096
    buffer_load_dwordx4 a[16:19], v15, s[16:19], s61 offen offset:0 sc1
    v_mfma_f32_16x16x32_bf16 v[76:79], a[40:43], v[24:27], v[76:79]
    v_mfma_f32_16x16x32_bf16 v[80:83], a[44:47], v[24:27], v[80:83]
    s_waitcnt lgkmcnt(1)
    v_mfma_f32_16x16x32_bf16 v[84:87], a[24:27], v[28:31], v[84:87]
    ds_read_b128 v[20:23], v216 offset:12288
    v_mfma_f32_16x16x32_bf16 v[88:91], a[28:31], v[28:31], v[88:91]
    buffer_load_dwordx4 a[20:23], v15, s[16:19], s61 offen offset:1024 sc1
    v_mfma_f32_16x16x32_bf16 v[92:95], a[32:35], v[28:31], v[92:95]
    v_mfma_f32_16x16x32_bf16 v[96:99], a[36:39], v[28:31], v[96:99]
    v_mfma_f32_16x16x32_bf16 v[100:103], a[40:43], v[28:31], v[100:103]
    v_mfma_f32_16x16x32_bf16 v[104:107], a[44:47], v[28:31], v[104:107]
    s_waitcnt lgkmcnt(1)
    v_mfma_f32_16x16x32_bf16 v[168:171], a[48:51], v[16:19], v[168:171]
    ds_read_b128 v[24:27], v218 offset:24576
    v_mfma_f32_16x16x32_bf16 v[172:175], a[52:55], v[16:19], v[172:175]
    buffer_load_dwordx4 a[24:27], v15, s[16:19], s61 offen offset:2048 sc1
    v_mfma_f32_16x16x32_bf16 v[176:179], a[56:59], v[16:19], v[176:179]
    v_mfma_f32_16x16x32_bf16 v[180:183], a[60:63], v[16:19], v[180:183]
    buffer_load_dwordx4 a[28:31], v15, s[16:19], s61 offen offset:3072 sc1
    v_mfma_f32_16x16x32_bf16 v[184:187], a[64:67], v[16:19], v[184:187]
    v_mfma_f32_16x16x32_bf16 v[188:191], a[68:71], v[16:19], v[188:191]
    s_waitcnt lgkmcnt(1)
    v_mfma_f32_16x16x32_bf16 v[192:195], a[48:51], v[20:23], v[192:195]
    ds_read_b128 v[28:31], v216 offset:36864
    v_mfma_f32_16x16x32_bf16 v[196:199], a[52:55], v[20:23], v[196:199]
    s_mov_b32 s61, 8192
    buffer_load_dwordx4 a[32:35], v15, s[16:19], s61 offen offset:0 sc1
    v_mfma_f32_16x16x32_bf16 v[200:203], a[56:59], v[20:23], v[200:203]
    v_mfma_f32_16x16x32_bf16 v[204:207], a[60:63], v[20:23], v[204:207]
    v_mfma_f32_16x16x32_bf16 v[208:211], a[64:67], v[20:23], v[208:211]
    v_mfma_f32_16x16x32_bf16 v[212:215], a[68:71], v[20:23], v[212:215]
    s_waitcnt lgkmcnt(1)
    v_mfma_f32_16x16x32_bf16 v[60:63], a[48:51], v[24:27], v[60:63]
    ds_read_b128 v[16:19], v219 offset:0
    v_mfma_f32_16x16x32_bf16 v[64:67], a[52:55], v[24:27], v[64:67]
    buffer_load_dwordx4 a[36:39], v15, s[16:19], s61 offen offset:1024 sc1
    v_mfma_f32_16x16x32_bf16 v[68:71], a[56:59], v[24:27], v[68:71]
    v_mfma_f32_16x16x32_bf16 v[72:75], a[60:63], v[24:27], v[72:75]
    buffer_load_dwordx4 a[40:43], v15, s[16:19], s61 offen offset:2048 sc1
    v_mfma_f32_16x16x32_bf16 v[76:79], a[64:67], v[24:27], v[76:79]
    v_mfma_f32_16x16x32_bf16 v[80:83], a[68:71], v[24:27], v[80:83]
    s_waitcnt lgkmcnt(1)
    v_mfma_f32_16x16x32_bf16 v[84:87], a[48:51], v[28:31], v[84:87]
    ds_read_b128 v[20:23], v217 offset:12288
    v_mfma_f32_16x16x32_bf16 v[88:91], a[52:55], v[28:31], v[88:91]
    buffer_load_dwordx4 a[44:47], v15, s[16:19], s61 offen offset:3072 sc1
    v_mfma_f32_16x16x32_bf16 v[92:95], a[56:59], v[28:31], v[92:95]
    v_mfma_f32_16x16x32_bf16 v[96:99], a[60:63], v[28:31], v[96:99]
    v_mfma_f32_16x16x32_bf16 v[100:103], a[64:67], v[28:31], v[100:103]
    v_mfma_f32_16x16x32_bf16 v[104:107], a[68:71], v[28:31], v[104:107]
    s_waitcnt lgkmcnt(1)
    v_mfma_f32_16x16x32_bf16 v[168:171], a[72:75], v[16:19], v[168:171]
    ds_read_b128 v[24:27], v219 offset:24576
    v_mfma_f32_16x16x32_bf16 v[172:175], a[76:79], v[16:19], v[172:175]
    s_mov_b32 s61, 12288
    buffer_load_dwordx4 a[48:51], v15, s[16:19], s61 offen offset:0 sc1
    v_mfma_f32_16x16x32_bf16 v[176:179], a[80:83], v[16:19], v[176:179]
    v_mfma_f32_16x16x32_bf16 v[180:183], a[84:87], v[16:19], v[180:183]
    buffer_load_dwordx4 a[52:55], v15, s[16:19], s61 offen offset:1024 sc1
    v_mfma_f32_16x16x32_bf16 v[184:187], a[88:91], v[16:19], v[184:187]
    v_mfma_f32_16x16x32_bf16 v[188:191], a[92:95], v[16:19], v[188:191]
    s_waitcnt lgkmcnt(1)
    v_mfma_f32_16x16x32_bf16 v[192:195], a[72:75], v[20:23], v[192:195]
    ds_read_b128 v[28:31], v217 offset:36864
    v_mfma_f32_16x16x32_bf16 v[196:199], a[76:79], v[20:23], v[196:199]
    buffer_load_dwordx4 a[56:59], v15, s[16:19], s61 offen offset:2048 sc1
    v_mfma_f32_16x16x32_bf16 v[200:203], a[80:83], v[20:23], v[200:203]
    v_mfma_f32_16x16x32_bf16 v[204:207], a[84:87], v[20:23], v[204:207]
    v_mfma_f32_16x16x32_bf16 v[208:211], a[88:91], v[20:23], v[208:211]
    v_mfma_f32_16x16x32_bf16 v[212:215], a[92:95], v[20:23], v[212:215]
    s_waitcnt lgkmcnt(1)
    v_mfma_f32_16x16x32_bf16 v[60:63], a[72:75], v[24:27], v[60:63]
    ds_read_b128 v[16:19], v216 offset:256
    v_mfma_f32_16x16x32_bf16 v[64:67], a[76:79], v[24:27], v[64:67]
    buffer_load_dwordx4 a[60:63], v15, s[16:19], s61 offen offset:3072 sc1
    v_mfma_f32_16x16x32_bf16 v[68:71], a[80:83], v[24:27], v[68:71]
    v_mfma_f32_16x16x32_bf16 v[72:75], a[84:87], v[24:27], v[72:75]
    s_mov_b32 s61, 16384
    buffer_load_dwordx4 a[64:67], v15, s[16:19], s61 offen offset:0 sc1
    v_mfma_f32_16x16x32_bf16 v[76:79], a[88:91], v[24:27], v[76:79]
    v_mfma_f32_16x16x32_bf16 v[80:83], a[92:95], v[24:27], v[80:83]
    s_waitcnt lgkmcnt(1)
    v_mfma_f32_16x16x32_bf16 v[84:87], a[72:75], v[28:31], v[84:87]
    ds_read_b128 v[20:23], v218 offset:12544
    v_mfma_f32_16x16x32_bf16 v[88:91], a[76:79], v[28:31], v[88:91]
    buffer_load_dwordx4 a[68:71], v15, s[16:19], s61 offen offset:1024 sc1
    v_mfma_f32_16x16x32_bf16 v[92:95], a[80:83], v[28:31], v[92:95]
    v_mfma_f32_16x16x32_bf16 v[96:99], a[84:87], v[28:31], v[96:99]
    v_mfma_f32_16x16x32_bf16 v[100:103], a[88:91], v[28:31], v[100:103]
    v_mfma_f32_16x16x32_bf16 v[104:107], a[92:95], v[28:31], v[104:107]
    s_waitcnt lgkmcnt(1)
    v_mfma_f32_16x16x32_bf16 v[168:171], a[96:99], v[16:19], v[168:171]
    ds_read_b128 v[24:27], v216 offset:24832
    v_mfma_f32_16x16x32_bf16 v[172:175], a[100:103], v[16:19], v[172:175]
    buffer_load_dwordx4 a[72:75], v15, s[16:19], s61 offen offset:2048 sc1
    v_mfma_f32_16x16x32_bf16 v[176:179], a[104:107], v[16:19], v[176:179]
    v_mfma_f32_16x16x32_bf16 v[180:183], a[108:111], v[16:19], v[180:183]
    buffer_load_dwordx4 a[76:79], v15, s[16:19], s61 offen offset:3072 sc1
    v_mfma_f32_16x16x32_bf16 v[184:187], a[112:115], v[16:19], v[184:187]
    v_mfma_f32_16x16x32_bf16 v[188:191], a[116:119], v[16:19], v[188:191]
    s_waitcnt lgkmcnt(1)
    v_mfma_f32_16x16x32_bf16 v[192:195], a[96:99], v[20:23], v[192:195]
    ds_read_b128 v[28:31], v218 offset:37120
    v_mfma_f32_16x16x32_bf16 v[196:199], a[100:103], v[20:23], v[196:199]
    s_mov_b32 s61, 20480
    buffer_load_dwordx4 a[80:83], v15, s[16:19], s61 offen offset:0 sc1
    v_mfma_f32_16x16x32_bf16 v[200:203], a[104:107], v[20:23], v[200:203]
    v_mfma_f32_16x16x32_bf16 v[204:207], a[108:111], v[20:23], v[204:207]
    v_mfma_f32_16x16x32_bf16 v[208:211], a[112:115], v[20:23], v[208:211]
    v_mfma_f32_16x16x32_bf16 v[212:215], a[116:119], v[20:23], v[212:215]
    s_waitcnt lgkmcnt(1)
    v_mfma_f32_16x16x32_bf16 v[60:63], a[96:99], v[24:27], v[60:63]
    ds_read_b128 v[16:19], v217 offset:256
    v_mfma_f32_16x16x32_bf16 v[64:67], a[100:103], v[24:27], v[64:67]
    buffer_load_dwordx4 a[84:87], v15, s[16:19], s61 offen offset:1024 sc1
    v_mfma_f32_16x16x32_bf16 v[68:71], a[104:107], v[24:27], v[68:71]
    v_mfma_f32_16x16x32_bf16 v[72:75], a[108:111], v[24:27], v[72:75]
    buffer_load_dwordx4 a[88:91], v15, s[16:19], s61 offen offset:2048 sc1
    v_mfma_f32_16x16x32_bf16 v[76:79], a[112:115], v[24:27], v[76:79]
    v_mfma_f32_16x16x32_bf16 v[80:83], a[116:119], v[24:27], v[80:83]
    s_waitcnt lgkmcnt(1)
    v_mfma_f32_16x16x32_bf16 v[84:87], a[96:99], v[28:31], v[84:87]
    ds_read_b128 v[20:23], v219 offset:12544
    v_mfma_f32_16x16x32_bf16 v[88:91], a[100:103], v[28:31], v[88:91]
    buffer_load_dwordx4 a[92:95], v15, s[16:19], s61 offen offset:3072 sc1
    v_mfma_f32_16x16x32_bf16 v[92:95], a[104:107], v[28:31], v[92:95]
    v_mfma_f32_16x16x32_bf16 v[96:99], a[108:111], v[28:31], v[96:99]
    v_mfma_f32_16x16x32_bf16 v[100:103], a[112:115], v[28:31], v[100:103]
    v_mfma_f32_16x16x32_bf16 v[104:107], a[116:119], v[28:31], v[104:107]
    s_waitcnt lgkmcnt(1)
    v_mfma_f32_16x16x32_bf16 v[168:171], a[120:123], v[16:19], v[168:171]
    ds_read_b128 v[24:27], v217 offset:24832
    v_mfma_f32_16x16x32_bf16 v[172:175], a[124:127], v[16:19], v[172:175]
    s_mov_b32 s61, 24576
    buffer_load_dwordx4 a[96:99], v15, s[16:19], s61 offen offset:0 sc1
    v_mfma_f32_16x16x32_bf16 v[176:179], a[128:131], v[16:19], v[176:179]
    v_mfma_f32_16x16x32_bf16 v[180:183], a[132:135], v[16:19], v[180:183]
    buffer_load_dwordx4 a[100:103], v15, s[16:19], s61 offen offset:1024 sc1
    v_mfma_f32_16x16x32_bf16 v[184:187], a[136:139], v[16:19], v[184:187]
    v_mfma_f32_16x16x32_bf16 v[188:191], a[140:143], v[16:19], v[188:191]
    s_waitcnt lgkmcnt(1)
    v_mfma_f32_16x16x32_bf16 v[192:195], a[120:123], v[20:23], v[192:195]
    ds_read_b128 v[28:31], v219 offset:37120
    v_mfma_f32_16x16x32_bf16 v[196:199], a[124:127], v[20:23], v[196:199]
    buffer_load_dwordx4 a[104:107], v15, s[16:19], s61 offen offset:2048 sc1
    v_mfma_f32_16x16x32_bf16 v[200:203], a[128:131], v[20:23], v[200:203]
    v_mfma_f32_16x16x32_bf16 v[204:207], a[132:135], v[20:23], v[204:207]
    v_mfma_f32_16x16x32_bf16 v[208:211], a[136:139], v[20:23], v[208:211]
    v_mfma_f32_16x16x32_bf16 v[212:215], a[140:143], v[20:23], v[212:215]
    s_waitcnt lgkmcnt(1)
    v_mfma_f32_16x16x32_bf16 v[60:63], a[120:123], v[24:27], v[60:63]
    ds_read_b128 v[16:19], v218 offset:256
    v_mfma_f32_16x16x32_bf16 v[64:67], a[124:127], v[24:27], v[64:67]
    buffer_load_dwordx4 a[108:111], v15, s[16:19], s61 offen offset:3072 sc1
    v_mfma_f32_16x16x32_bf16 v[68:71], a[128:131], v[24:27], v[68:71]
    v_mfma_f32_16x16x32_bf16 v[72:75], a[132:135], v[24:27], v[72:75]
    s_mov_b32 s61, 28672
    buffer_load_dwordx4 a[112:115], v15, s[16:19], s61 offen offset:0 sc1
    v_mfma_f32_16x16x32_bf16 v[76:79], a[136:139], v[24:27], v[76:79]
    v_mfma_f32_16x16x32_bf16 v[80:83], a[140:143], v[24:27], v[80:83]
    s_waitcnt lgkmcnt(1)
    v_mfma_f32_16x16x32_bf16 v[84:87], a[120:123], v[28:31], v[84:87]
    ds_read_b128 v[20:23], v216 offset:12544
    v_mfma_f32_16x16x32_bf16 v[88:91], a[124:127], v[28:31], v[88:91]
    buffer_load_dwordx4 a[116:119], v15, s[16:19], s61 offen offset:1024 sc1
    v_mfma_f32_16x16x32_bf16 v[92:95], a[128:131], v[28:31], v[92:95]
    v_mfma_f32_16x16x32_bf16 v[96:99], a[132:135], v[28:31], v[96:99]
    v_mfma_f32_16x16x32_bf16 v[100:103], a[136:139], v[28:31], v[100:103]
    v_mfma_f32_16x16x32_bf16 v[104:107], a[140:143], v[28:31], v[104:107]
    s_waitcnt lgkmcnt(1)
    v_mfma_f32_16x16x32_bf16 v[168:171], a[144:147], v[16:19], v[168:171]
    ds_read_b128 v[24:27], v218 offset:24832
    v_mfma_f32_16x16x32_bf16 v[172:175], a[148:151], v[16:19], v[172:175]
    buffer_load_dwordx4 a[120:123], v15, s[16:19], s61 offen offset:2048 sc1
    v_mfma_f32_16x16x32_bf16 v[176:179], a[152:155], v[16:19], v[176:179]
    v_mfma_f32_16x16x32_bf16 v[180:183], a[156:159], v[16:19], v[180:183]
    buffer_load_dwordx4 a[124:127], v15, s[16:19], s61 offen offset:3072 sc1
    v_mfma_f32_16x16x32_bf16 v[184:187], a[160:163], v[16:19], v[184:187]
    v_mfma_f32_16x16x32_bf16 v[188:191], a[164:167], v[16:19], v[188:191]
    s_waitcnt lgkmcnt(1)
    v_mfma_f32_16x16x32_bf16 v[192:195], a[144:147], v[20:23], v[192:195]
    ds_read_b128 v[28:31], v216 offset:37120
    v_mfma_f32_16x16x32_bf16 v[196:199], a[148:151], v[20:23], v[196:199]
    s_mov_b32 s61, 32768
    buffer_load_dwordx4 a[128:131], v15, s[16:19], s61 offen offset:0 sc1
    v_mfma_f32_16x16x32_bf16 v[200:203], a[152:155], v[20:23], v[200:203]
    v_mfma_f32_16x16x32_bf16 v[204:207], a[156:159], v[20:23], v[204:207]
    v_mfma_f32_16x16x32_bf16 v[208:211], a[160:163], v[20:23], v[208:211]
    v_mfma_f32_16x16x32_bf16 v[212:215], a[164:167], v[20:23], v[212:215]
    s_waitcnt lgkmcnt(1)
    v_mfma_f32_16x16x32_bf16 v[60:63], a[144:147], v[24:27], v[60:63]
    ds_read_b128 v[16:19], v219 offset:256
    v_mfma_f32_16x16x32_bf16 v[64:67], a[148:151], v[24:27], v[64:67]
    buffer_load_dwordx4 a[132:135], v15, s[16:19], s61 offen offset:1024 sc1
    v_mfma_f32_16x16x32_bf16 v[68:71], a[152:155], v[24:27], v[68:71]
    v_mfma_f32_16x16x32_bf16 v[72:75], a[156:159], v[24:27], v[72:75]
    buffer_load_dwordx4 a[136:139], v15, s[16:19], s61 offen offset:2048 sc1
    v_mfma_f32_16x16x32_bf16 v[76:79], a[160:163], v[24:27], v[76:79]
    v_mfma_f32_16x16x32_bf16 v[80:83], a[164:167], v[24:27], v[80:83]
    s_waitcnt lgkmcnt(1)
    v_mfma_f32_16x16x32_bf16 v[84:87], a[144:147], v[28:31], v[84:87]
    ds_read_b128 v[20:23], v217 offset:12544
    v_mfma_f32_16x16x32_bf16 v[88:91], a[148:151], v[28:31], v[88:91]
    buffer_load_dwordx4 a[140:143], v15, s[16:19], s61 offen offset:3072 sc1
    v_mfma_f32_16x16x32_bf16 v[92:95], a[152:155], v[28:31], v[92:95]
    v_mfma_f32_16x16x32_bf16 v[96:99], a[156:159], v[28:31], v[96:99]
    v_mfma_f32_16x16x32_bf16 v[100:103], a[160:163], v[28:31], v[100:103]
    v_mfma_f32_16x16x32_bf16 v[104:107], a[164:167], v[28:31], v[104:107]
    s_waitcnt lgkmcnt(1)
    v_mfma_f32_16x16x32_bf16 v[168:171], a[168:171], v[16:19], v[168:171]
    ds_read_b128 v[24:27], v219 offset:24832
    v_mfma_f32_16x16x32_bf16 v[172:175], a[172:175], v[16:19], v[172:175]
    s_mov_b32 s61, 36864
    buffer_load_dwordx4 a[144:147], v15, s[16:19], s61 offen offset:0 sc1
    v_mfma_f32_16x16x32_bf16 v[176:179], a[176:179], v[16:19], v[176:179]
    v_mfma_f32_16x16x32_bf16 v[180:183], a[180:183], v[16:19], v[180:183]
    buffer_load_dwordx4 a[148:151], v15, s[16:19], s61 offen offset:1024 sc1
    v_mfma_f32_16x16x32_bf16 v[184:187], a[184:187], v[16:19], v[184:187]
    v_mfma_f32_16x16x32_bf16 v[188:191], a[188:191], v[16:19], v[188:191]
    s_waitcnt lgkmcnt(1)
    v_mfma_f32_16x16x32_bf16 v[192:195], a[168:171], v[20:23], v[192:195]
    ds_read_b128 v[28:31], v217 offset:37120
    v_mfma_f32_16x16x32_bf16 v[196:199], a[172:175], v[20:23], v[196:199]
    buffer_load_dwordx4 a[152:155], v15, s[16:19], s61 offen offset:2048 sc1
    v_mfma_f32_16x16x32_bf16 v[200:203], a[176:179], v[20:23], v[200:203]
    v_mfma_f32_16x16x32_bf16 v[204:207], a[180:183], v[20:23], v[204:207]
    v_mfma_f32_16x16x32_bf16 v[208:211], a[184:187], v[20:23], v[208:211]
    v_mfma_f32_16x16x32_bf16 v[212:215], a[188:191], v[20:23], v[212:215]
    s_waitcnt lgkmcnt(1)
    v_mfma_f32_16x16x32_bf16 v[60:63], a[168:171], v[24:27], v[60:63]
    ds_read_b128 v[16:19], v216 offset:512
    v_mfma_f32_16x16x32_bf16 v[64:67], a[172:175], v[24:27], v[64:67]
    buffer_load_dwordx4 a[156:159], v15, s[16:19], s61 offen offset:3072 sc1
    v_mfma_f32_16x16x32_bf16 v[68:71], a[176:179], v[24:27], v[68:71]
    v_mfma_f32_16x16x32_bf16 v[72:75], a[180:183], v[24:27], v[72:75]
    s_mov_b32 s61, 40960
    buffer_load_dwordx4 a[160:163], v15, s[16:19], s61 offen offset:0 sc1
    v_mfma_f32_16x16x32_bf16 v[76:79], a[184:187], v[24:27], v[76:79]
    v_mfma_f32_16x16x32_bf16 v[80:83], a[188:191], v[24:27], v[80:83]
    s_waitcnt lgkmcnt(1)
    v_mfma_f32_16x16x32_bf16 v[84:87], a[168:171], v[28:31], v[84:87]
    ds_read_b128 v[20:23], v218 offset:12800
    v_mfma_f32_16x16x32_bf16 v[88:91], a[172:175], v[28:31], v[88:91]
    buffer_load_dwordx4 a[164:167], v15, s[16:19], s61 offen offset:1024 sc1
    v_mfma_f32_16x16x32_bf16 v[92:95], a[176:179], v[28:31], v[92:95]
    v_mfma_f32_16x16x32_bf16 v[96:99], a[180:183], v[28:31], v[96:99]
    v_mfma_f32_16x16x32_bf16 v[100:103], a[184:187], v[28:31], v[100:103]
    v_mfma_f32_16x16x32_bf16 v[104:107], a[188:191], v[28:31], v[104:107]
    s_waitcnt lgkmcnt(1)
    v_mfma_f32_16x16x32_bf16 v[168:171], a[192:195], v[16:19], v[168:171]
    ds_read_b128 v[24:27], v216 offset:25088
    v_mfma_f32_16x16x32_bf16 v[172:175], a[196:199], v[16:19], v[172:175]
    buffer_load_dwordx4 a[168:171], v15, s[16:19], s61 offen offset:2048 sc1
    v_mfma_f32_16x16x32_bf16 v[176:179], a[200:203], v[16:19], v[176:179]
    v_mfma_f32_16x16x32_bf16 v[180:183], a[204:207], v[16:19], v[180:183]
    buffer_load_dwordx4 a[172:175], v15, s[16:19], s61 offen offset:3072 sc1
    v_mfma_f32_16x16x32_bf16 v[184:187], a[208:211], v[16:19], v[184:187]
    v_mfma_f32_16x16x32_bf16 v[188:191], a[212:215], v[16:19], v[188:191]
    s_waitcnt lgkmcnt(1)
    v_mfma_f32_16x16x32_bf16 v[192:195], a[192:195], v[20:23], v[192:195]
    ds_read_b128 v[28:31], v218 offset:37376
    v_mfma_f32_16x16x32_bf16 v[196:199], a[196:199], v[20:23], v[196:199]
    s_mov_b32 s61, 45056
    buffer_load_dwordx4 a[176:179], v15, s[16:19], s61 offen offset:0 sc1
    v_mfma_f32_16x16x32_bf16 v[200:203], a[200:203], v[20:23], v[200:203]
    v_mfma_f32_16x16x32_bf16 v[204:207], a[204:207], v[20:23], v[204:207]
    v_mfma_f32_16x16x32_bf16 v[208:211], a[208:211], v[20:23], v[208:211]
    v_mfma_f32_16x16x32_bf16 v[212:215], a[212:215], v[20:23], v[212:215]
    s_waitcnt lgkmcnt(1)
    v_mfma_f32_16x16x32_bf16 v[60:63], a[192:195], v[24:27], v[60:63]
    ds_read_b128 v[16:19], v217 offset:512
    v_mfma_f32_16x16x32_bf16 v[64:67], a[196:199], v[24:27], v[64:67]
    buffer_load_dwordx4 a[180:183], v15, s[16:19], s61 offen offset:1024 sc1
    v_mfma_f32_16x16x32_bf16 v[68:71], a[200:203], v[24:27], v[68:71]
    v_mfma_f32_16x16x32_bf16 v[72:75], a[204:207], v[24:27], v[72:75]
    buffer_load_dwordx4 a[184:187], v15, s[16:19], s61 offen offset:2048 sc1
    v_mfma_f32_16x16x32_bf16 v[76:79], a[208:211], v[24:27], v[76:79]
    v_mfma_f32_16x16x32_bf16 v[80:83], a[212:215], v[24:27], v[80:83]
    s_waitcnt lgkmcnt(1)
    v_mfma_f32_16x16x32_bf16 v[84:87], a[192:195], v[28:31], v[84:87]
    ds_read_b128 v[20:23], v219 offset:12800
    v_mfma_f32_16x16x32_bf16 v[88:91], a[196:199], v[28:31], v[88:91]
    buffer_load_dwordx4 a[188:191], v15, s[16:19], s61 offen offset:3072 sc1
    v_mfma_f32_16x16x32_bf16 v[92:95], a[200:203], v[28:31], v[92:95]
    v_mfma_f32_16x16x32_bf16 v[96:99], a[204:207], v[28:31], v[96:99]
    v_mfma_f32_16x16x32_bf16 v[100:103], a[208:211], v[28:31], v[100:103]
    v_mfma_f32_16x16x32_bf16 v[104:107], a[212:215], v[28:31], v[104:107]
    s_waitcnt lgkmcnt(1)
    v_mfma_f32_16x16x32_bf16 v[168:171], a[216:219], v[16:19], v[168:171]
    ds_read_b128 v[24:27], v217 offset:25088
    v_mfma_f32_16x16x32_bf16 v[172:175], a[220:223], v[16:19], v[172:175]
    s_mov_b32 s61, 49152
    buffer_load_dwordx4 a[192:195], v15, s[16:19], s61 offen offset:0 sc1
    v_mfma_f32_16x16x32_bf16 v[176:179], a[224:227], v[16:19], v[176:179]
    v_mfma_f32_16x16x32_bf16 v[180:183], a[228:231], v[16:19], v[180:183]
    buffer_load_dwordx4 a[196:199], v15, s[16:19], s61 offen offset:1024 sc1
    v_mfma_f32_16x16x32_bf16 v[184:187], a[232:235], v[16:19], v[184:187]
    v_mfma_f32_16x16x32_bf16 v[188:191], a[236:239], v[16:19], v[188:191]
    s_waitcnt lgkmcnt(1)
    v_mfma_f32_16x16x32_bf16 v[192:195], a[216:219], v[20:23], v[192:195]
    ds_read_b128 v[28:31], v219 offset:37376
    v_mfma_f32_16x16x32_bf16 v[196:199], a[220:223], v[20:23], v[196:199]
    buffer_load_dwordx4 a[200:203], v15, s[16:19], s61 offen offset:2048 sc1
    v_mfma_f32_16x16x32_bf16 v[200:203], a[224:227], v[20:23], v[200:203]
    v_mfma_f32_16x16x32_bf16 v[204:207], a[228:231], v[20:23], v[204:207]
    v_mfma_f32_16x16x32_bf16 v[208:211], a[232:235], v[20:23], v[208:211]
    v_mfma_f32_16x16x32_bf16 v[212:215], a[236:239], v[20:23], v[212:215]
    s_waitcnt lgkmcnt(1)
    v_mfma_f32_16x16x32_bf16 v[60:63], a[216:219], v[24:27], v[60:63]
    ds_read_b128 v[16:19], v218 offset:512
    v_mfma_f32_16x16x32_bf16 v[64:67], a[220:223], v[24:27], v[64:67]
    buffer_load_dwordx4 a[204:207], v15, s[16:19], s61 offen offset:3072 sc1
    v_mfma_f32_16x16x32_bf16 v[68:71], a[224:227], v[24:27], v[68:71]
    v_mfma_f32_16x16x32_bf16 v[72:75], a[228:231], v[24:27], v[72:75]
    s_mov_b32 s61, 53248
    buffer_load_dwordx4 a[208:211], v15, s[16:19], s61 offen offset:0 sc1
    v_mfma_f32_16x16x32_bf16 v[76:79], a[232:235], v[24:27], v[76:79]
    v_mfma_f32_16x16x32_bf16 v[80:83], a[236:239], v[24:27], v[80:83]
    s_waitcnt lgkmcnt(1)
    v_mfma_f32_16x16x32_bf16 v[84:87], a[216:219], v[28:31], v[84:87]
    ds_read_b128 v[20:23], v216 offset:12800
    v_mfma_f32_16x16x32_bf16 v[88:91], a[220:223], v[28:31], v[88:91]
    buffer_load_dwordx4 a[212:215], v15, s[16:19], s61 offen offset:1024 sc1
    v_mfma_f32_16x16x32_bf16 v[92:95], a[224:227], v[28:31], v[92:95]
    v_mfma_f32_16x16x32_bf16 v[96:99], a[228:231], v[28:31], v[96:99]
    v_mfma_f32_16x16x32_bf16 v[100:103], a[232:235], v[28:31], v[100:103]
    v_mfma_f32_16x16x32_bf16 v[104:107], a[236:239], v[28:31], v[104:107]
    s_waitcnt lgkmcnt(1)
    v_mfma_f32_16x16x32_bf16 v[168:171], a[240:243], v[16:19], v[168:171]
    ds_read_b128 v[24:27], v218 offset:25088
    v_mfma_f32_16x16x32_bf16 v[172:175], a[244:247], v[16:19], v[172:175]
    buffer_load_dwordx4 a[216:219], v15, s[16:19], s61 offen offset:2048 sc1
    v_mfma_f32_16x16x32_bf16 v[176:179], a[248:251], v[16:19], v[176:179]
    v_mfma_f32_16x16x32_bf16 v[180:183], a[252:255], v[16:19], v[180:183]
    buffer_load_dwordx4 a[220:223], v15, s[16:19], s61 offen offset:3072 sc1
    v_mfma_f32_16x16x32_bf16 v[184:187], v[224:227], v[16:19], v[184:187]
    v_mfma_f32_16x16x32_bf16 v[188:191], v[228:231], v[16:19], v[188:191]
    s_waitcnt lgkmcnt(1)
    v_mfma_f32_16x16x32_bf16 v[192:195], a[240:243], v[20:23], v[192:195]
    ds_read_b128 v[28:31], v216 offset:37376
    v_mfma_f32_16x16x32_bf16 v[196:199], a[244:247], v[20:23], v[196:199]
    s_mov_b32 s61, 57344
    buffer_load_dwordx4 a[224:227], v15, s[16:19], s61 offen offset:0 sc1
    v_mfma_f32_16x16x32_bf16 v[200:203], a[248:251], v[20:23], v[200:203]
    v_mfma_f32_16x16x32_bf16 v[204:207], a[252:255], v[20:23], v[204:207]
    v_mfma_f32_16x16x32_bf16 v[208:211], v[224:227], v[20:23], v[208:211]
    v_mfma_f32_16x16x32_bf16 v[212:215], v[228:231], v[20:23], v[212:215]
    s_waitcnt lgkmcnt(1)
    v_mfma_f32_16x16x32_bf16 v[60:63], a[240:243], v[24:27], v[60:63]
    ds_read_b128 v[16:19], v219 offset:512
    v_mfma_f32_16x16x32_bf16 v[64:67], a[244:247], v[24:27], v[64:67]
    buffer_load_dwordx4 a[228:231], v15, s[16:19], s61 offen offset:1024 sc1
    v_mfma_f32_16x16x32_bf16 v[68:71], a[248:251], v[24:27], v[68:71]
    v_mfma_f32_16x16x32_bf16 v[72:75], a[252:255], v[24:27], v[72:75]
    buffer_load_dwordx4 a[232:235], v15, s[16:19], s61 offen offset:2048 sc1
    v_mfma_f32_16x16x32_bf16 v[76:79], v[224:227], v[24:27], v[76:79]
    v_mfma_f32_16x16x32_bf16 v[80:83], v[228:231], v[24:27], v[80:83]
    s_waitcnt lgkmcnt(1)
    v_mfma_f32_16x16x32_bf16 v[84:87], a[240:243], v[28:31], v[84:87]
    ds_read_b128 v[20:23], v217 offset:12800
    v_mfma_f32_16x16x32_bf16 v[88:91], a[244:247], v[28:31], v[88:91]
    buffer_load_dwordx4 a[236:239], v15, s[16:19], s61 offen offset:3072 sc1
    v_mfma_f32_16x16x32_bf16 v[92:95], a[248:251], v[28:31], v[92:95]
    v_mfma_f32_16x16x32_bf16 v[96:99], a[252:255], v[28:31], v[96:99]
    v_mfma_f32_16x16x32_bf16 v[100:103], v[224:227], v[28:31], v[100:103]
    v_mfma_f32_16x16x32_bf16 v[104:107], v[228:231], v[28:31], v[104:107]
    s_waitcnt lgkmcnt(1)
    s_barrier
    v_mfma_f32_16x16x32_bf16 v[168:171], v[232:235], v[16:19], v[168:171]
    ds_read_b128 v[24:27], v219 offset:25088
    v_mfma_f32_16x16x32_bf16 v[172:175], v[236:239], v[16:19], v[172:175]
    s_mov_b32 s61, 61440
    buffer_load_dwordx4 a[240:243], v15, s[16:19], s61 offen offset:0 sc1
    v_mfma_f32_16x16x32_bf16 v[176:179], v[240:243], v[16:19], v[176:179]
    v_mfma_f32_16x16x32_bf16 v[180:183], v[244:247], v[16:19], v[180:183]
    buffer_load_dwordx4 a[244:247], v15, s[16:19], s61 offen offset:1024 sc1
    v_mfma_f32_16x16x32_bf16 v[184:187], v[248:251], v[16:19], v[184:187]
    v_mfma_f32_16x16x32_bf16 v[188:191], v[252:255], v[16:19], v[188:191]
    s_waitcnt lgkmcnt(1)
    v_mfma_f32_16x16x32_bf16 v[192:195], v[232:235], v[20:23], v[192:195]
    ds_read_b128 v[28:31], v217 offset:37376
    v_mfma_f32_16x16x32_bf16 v[196:199], v[236:239], v[20:23], v[196:199]
    buffer_load_dwordx4 a[248:251], v15, s[16:19], s61 offen offset:2048 sc1
    v_mfma_f32_16x16x32_bf16 v[200:203], v[240:243], v[20:23], v[200:203]
    v_mfma_f32_16x16x32_bf16 v[204:207], v[244:247], v[20:23], v[204:207]
    v_mfma_f32_16x16x32_bf16 v[208:211], v[248:251], v[20:23], v[208:211]
    v_mfma_f32_16x16x32_bf16 v[212:215], v[252:255], v[20:23], v[212:215]
    s_waitcnt lgkmcnt(1)
    v_mfma_f32_16x16x32_bf16 v[60:63], v[232:235], v[24:27], v[60:63]
    ds_read_b128 v[16:19], v6 offset:0
    v_mfma_f32_16x16x32_bf16 v[64:67], v[236:239], v[24:27], v[64:67]
    buffer_load_dwordx4 a[252:255], v15, s[16:19], s61 offen offset:3072 sc1
    v_mfma_f32_16x16x32_bf16 v[68:71], v[240:243], v[24:27], v[68:71]
    v_mfma_f32_16x16x32_bf16 v[72:75], v[244:247], v[24:27], v[72:75]
    s_mov_b32 s61, 65536
    buffer_load_dwordx4 v[224:227], v15, s[16:19], s61 offen offset:0 sc1
    v_mfma_f32_16x16x32_bf16 v[76:79], v[248:251], v[24:27], v[76:79]
    v_mfma_f32_16x16x32_bf16 v[80:83], v[252:255], v[24:27], v[80:83]
    s_waitcnt lgkmcnt(1)
    v_mfma_f32_16x16x32_bf16 v[84:87], v[232:235], v[28:31], v[84:87]
    ds_read_b128 v[20:23], v7 offset:0
    v_mfma_f32_16x16x32_bf16 v[88:91], v[236:239], v[28:31], v[88:91]
    buffer_load_dwordx4 v[228:231], v15, s[16:19], s61 offen offset:1024 sc1
    v_mfma_f32_16x16x32_bf16 v[92:95], v[240:243], v[28:31], v[92:95]
    v_mfma_f32_16x16x32_bf16 v[96:99], v[244:247], v[28:31], v[96:99]
    v_mfma_f32_16x16x32_bf16 v[100:103], v[248:251], v[28:31], v[100:103]
    v_mfma_f32_16x16x32_bf16 v[104:107], v[252:255], v[28:31], v[104:107]
    s_waitcnt lgkmcnt(1)
    s_waitcnt vmcnt(63)
    v_mfma_f32_16x16x32_bf16 v[36:39], a[0:3], v[16:19], 0
    ds_read_b128 v[24:27], v8 offset:0
    s_waitcnt lgkmcnt(1)
    s_waitcnt vmcnt(59)
    v_mfma_f32_16x16x32_bf16 v[36:39], a[24:27], v[20:23], v[36:39]
    ds_read_b128 v[28:31], v9 offset:0
    v_mfma_f32_16x16x32_bf16 v[40:43], a[4:7], v[16:19], 0
    buffer_load_dwordx4 v[232:235], v15, s[16:19], s61 offen offset:2048 sc1
    buffer_load_dwordx4 v[236:239], v15, s[16:19], s61 offen offset:3072 sc1
    s_waitcnt vmcnt(60)
    v_mfma_f32_16x16x32_bf16 v[40:43], a[28:31], v[20:23], v[40:43]
    s_mov_b32 s61, 69632
    buffer_load_dwordx4 v[240:243], v15, s[16:19], s61 offen offset:0 sc1
    v_mfma_f32_16x16x32_bf16 v[44:47], a[8:11], v[16:19], 0
    buffer_load_dwordx4 v[244:247], v15, s[16:19], s61 offen offset:1024 sc1
    s_waitcnt vmcnt(61)
    v_mfma_f32_16x16x32_bf16 v[44:47], a[32:35], v[20:23], v[44:47]
    buffer_load_dwordx4 v[248:251], v15, s[16:19], s61 offen offset:2048 sc1
    buffer_load_dwordx4 v[252:255], v15, s[16:19], s61 offen offset:3072 sc1
    v_mfma_f32_16x16x32_bf16 v[48:51], a[12:15], v[16:19], 0
    v_cvt_pk_bf16_f32 v168, v168, v169
    s_waitcnt vmcnt(62)
    v_mfma_f32_16x16x32_bf16 v[48:51], a[36:39], v[20:23], v[48:51]
    v_cvt_pk_bf16_f32 v169, v170, v171
    v_mfma_f32_16x16x32_bf16 v[52:55], a[16:19], v[16:19], 0
    v_cvt_pk_bf16_f32 v170, v172, v173
    v_cvt_pk_bf16_f32 v171, v174, v175
    s_waitcnt vmcnt(61)
    v_mfma_f32_16x16x32_bf16 v[52:55], a[40:43], v[20:23], v[52:55]
    v_cvt_pk_bf16_f32 v172, v176, v177
    v_mfma_f32_16x16x32_bf16 v[56:59], a[20:23], v[16:19], 0
    v_cvt_pk_bf16_f32 v173, v178, v179
    s_waitcnt vmcnt(60)
    v_mfma_f32_16x16x32_bf16 v[56:59], a[44:47], v[20:23], v[56:59]
    v_cvt_pk_bf16_f32 v174, v180, v181
    s_waitcnt lgkmcnt(1)
    s_barrier
    s_waitcnt vmcnt(59)
    v_mfma_f32_16x16x32_bf16 v[36:39], a[48:51], v[24:27], v[36:39]
    ds_read_b128 v[16:19], v6 offset:256
    s_waitcnt lgkmcnt(1)
    s_waitcnt vmcnt(53)
    v_mfma_f32_16x16x32_bf16 v[36:39], a[72:75], v[28:31], v[36:39]
    ds_read_b128 v[20:23], v7 offset:256
    v_mfma_f32_16x16x32_bf16 v[40:43], a[52:55], v[24:27], v[40:43]
    s_mov_b32 s72, s8
    s_mov_b32 s73, s9
    s_mov_b32 s74, s10
    s_mov_b32 s76, s43
    s_add_u32 s77, s36, 49152
    s_add_u32 m0, s77, 0
    s_nop 0
    buffer_load_dwordx4 v0, s[72:75], s76 offen offset:0 nt lds
    s_waitcnt vmcnt(53)
    v_mfma_f32_16x16x32_bf16 v[40:43], a[76:79], v[28:31], v[40:43]
    v_cvt_pk_bf16_f32 v175, v182, v183
    v_cvt_pk_bf16_f32 v176, v184, v185
    v_mfma_f32_16x16x32_bf16 v[44:47], a[56:59], v[24:27], v[44:47]
    v_cvt_pk_bf16_f32 v177, v186, v187
    v_cvt_pk_bf16_f32 v178, v188, v189
    s_waitcnt vmcnt(52)
    v_mfma_f32_16x16x32_bf16 v[44:47], a[80:83], v[28:31], v[44:47]
    v_cvt_pk_bf16_f32 v179, v190, v191
    v_mfma_f32_16x16x32_bf16 v[48:51], a[60:63], v[24:27], v[48:51]
    v_cvt_pk_bf16_f32 v180, v192, v193
    v_cvt_pk_bf16_f32 v181, v194, v195
    s_waitcnt vmcnt(51)
    v_mfma_f32_16x16x32_bf16 v[48:51], a[84:87], v[28:31], v[48:51]
    s_add_u32 m0, s77, 0
    s_nop 0
    buffer_load_dwordx4 v1, s[72:75], s76 offen offset:1024 nt lds
    v_cvt_pk_bf16_f32 v182, v196, v197
    v_mfma_f32_16x16x32_bf16 v[52:55], a[64:67], v[24:27], v[52:55]
    v_cvt_pk_bf16_f32 v183, v198, v199
    s_waitcnt vmcnt(51)
    v_mfma_f32_16x16x32_bf16 v[52:55], a[88:91], v[28:31], v[52:55]
    v_cvt_pk_bf16_f32 v184, v200, v201
    v_cvt_pk_bf16_f32 v185, v202, v203
    v_mfma_f32_16x16x32_bf16 v[56:59], a[68:71], v[24:27], v[56:59]
    v_cvt_pk_bf16_f32 v186, v204, v205
    v_cvt_pk_bf16_f32 v187, v206, v207
    s_waitcnt vmcnt(50)
    v_mfma_f32_16x16x32_bf16 v[56:59], a[92:95], v[28:31], v[56:59]
    v_cvt_pk_bf16_f32 v188, v208, v209
    s_waitcnt lgkmcnt(1)
    s_waitcnt vmcnt(49)
    v_mfma_f32_16x16x32_bf16 v[36:39], a[96:99], v[16:19], v[36:39]
    ds_read_b128 v[24:27], v8 offset:256
    s_waitcnt lgkmcnt(1)
    s_waitcnt vmcnt(43)
    v_mfma_f32_16x16x32_bf16 v[36:39], a[120:123], v[20:23], v[36:39]
    ds_read_b128 v[28:31], v9 offset:256
    v_mfma_f32_16x16x32_bf16 v[40:43], a[100:103], v[16:19], v[40:43]
    v_cvt_pk_bf16_f32 v189, v210, v211
    v_cvt_pk_bf16_f32 v190, v212, v213
    s_waitcnt vmcnt(42)
    v_mfma_f32_16x16x32_bf16 v[40:43], a[124:127], v[20:23], v[40:43]
    v_cvt_pk_bf16_f32 v191, v214, v215
    v_mfma_f32_16x16x32_bf16 v[44:47], a[104:107], v[16:19], v[44:47]
    v_cvt_pk_bf16_f32 v192, v60, v61
    v_cvt_pk_bf16_f32 v193, v62, v63
    s_waitcnt vmcnt(41)
    v_mfma_f32_16x16x32_bf16 v[44:47], a[128:131], v[20:23], v[44:47]
    v_cvt_pk_bf16_f32 v194, v64, v65
    v_mfma_f32_16x16x32_bf16 v[48:51], a[108:111], v[16:19], v[48:51]
    v_cvt_pk_bf16_f32 v195, v66, v67
    s_add_u32 m0, s77, 0
    s_nop 0
    buffer_load_dwordx4 v2, s[72:75], s76 offen offset:2048 nt lds
    s_waitcnt vmcnt(41)
    v_mfma_f32_16x16x32_bf16 v[48:51], a[132:135], v[20:23], v[48:51]
    v_cvt_pk_bf16_f32 v196, v68, v69
    v_mfma_f32_16x16x32_bf16 v[52:55], a[112:115], v[16:19], v[52:55]
    v_cvt_pk_bf16_f32 v197, v70, v71
    v_cvt_pk_bf16_f32 v198, v72, v73
    s_waitcnt vmcnt(40)
    v_mfma_f32_16x16x32_bf16 v[52:55], a[136:139], v[20:23], v[52:55]
    v_cvt_pk_bf16_f32 v199, v74, v75
    v_mfma_f32_16x16x32_bf16 v[56:59], a[116:119], v[16:19], v[56:59]
    v_cvt_pk_bf16_f32 v200, v76, v77
    v_cvt_pk_bf16_f32 v201, v78, v79
    s_waitcnt vmcnt(39)
    v_mfma_f32_16x16x32_bf16 v[56:59], a[140:143], v[20:23], v[56:59]
    v_cvt_pk_bf16_f32 v202, v80, v81
    s_waitcnt lgkmcnt(1)
    s_waitcnt vmcnt(38)
    v_mfma_f32_16x16x32_bf16 v[36:39], a[144:147], v[24:27], v[36:39]
    ds_read_b128 v[16:19], v6 offset:512
    s_waitcnt lgkmcnt(1)
    s_waitcnt vmcnt(32)
    v_mfma_f32_16x16x32_bf16 v[36:39], a[168:171], v[28:31], v[36:39]
    ds_read_b128 v[20:23], v7 offset:512
    v_mfma_f32_16x16x32_bf16 v[40:43], a[148:151], v[24:27], v[40:43]
    s_add_u32 m0, s77, 3072
    s_nop 0
    buffer_load_dwordx4 v3, s[72:75], s76 offen offset:0 nt lds
    v_cvt_pk_bf16_f32 v203, v82, v83
    s_waitcnt vmcnt(32)
    v_mfma_f32_16x16x32_bf16 v[40:43], a[172:175], v[28:31], v[40:43]
    v_cvt_pk_bf16_f32 v204, v84, v85
    v_mfma_f32_16x16x32_bf16 v[44:47], a[152:155], v[24:27], v[44:47]
    v_cvt_pk_bf16_f32 v205, v86, v87
    v_cvt_pk_bf16_f32 v206, v88, v89
    s_waitcnt vmcnt(31)
    v_mfma_f32_16x16x32_bf16 v[44:47], a[176:179], v[28:31], v[44:47]
    v_cvt_pk_bf16_f32 v207, v90, v91
    v_mfma_f32_16x16x32_bf16 v[48:51], a[156:159], v[24:27], v[48:51]
    v_cvt_pk_bf16_f32 v208, v92, v93
    v_cvt_pk_bf16_f32 v209, v94, v95
    s_waitcnt vmcnt(30)
    v_mfma_f32_16x16x32_bf16 v[48:51], a[180:183], v[28:31], v[48:51]
    v_cvt_pk_bf16_f32 v210, v96, v97
    v_mfma_f32_16x16x32_bf16 v[52:55], a[160:163], v[24:27], v[52:55]
    v_cvt_pk_bf16_f32 v211, v98, v99
    v_cvt_pk_bf16_f32 v212, v100, v101
    s_waitcnt vmcnt(29)
    v_mfma_f32_16x16x32_bf16 v[52:55], a[184:187], v[28:31], v[52:55]
    v_cvt_pk_bf16_f32 v213, v102, v103
    v_mfma_f32_16x16x32_bf16 v[56:59], a[164:167], v[24:27], v[56:59]
    v_cvt_pk_bf16_f32 v214, v104, v105
    v_cvt_pk_bf16_f32 v215, v106, v107
    s_waitcnt vmcnt(28)
    v_mfma_f32_16x16x32_bf16 v[56:59], a[188:191], v[28:31], v[56:59]
    v_lshlrev_b32 v84, 16, v108
    s_waitcnt lgkmcnt(1)
    s_waitcnt vmcnt(27)
    v_mfma_f32_16x16x32_bf16 v[36:39], a[192:195], v[16:19], v[36:39]
    ds_read_b128 v[24:27], v8 offset:512
    s_waitcnt lgkmcnt(1)
    s_waitcnt vmcnt(21)
    v_mfma_f32_16x16x32_bf16 v[36:39], a[216:219], v[20:23], v[36:39]
    ds_read_b128 v[28:31], v9 offset:512
    v_mfma_f32_16x16x32_bf16 v[40:43], a[196:199], v[16:19], v[40:43]
    s_add_u32 m0, s77, 3072
    s_nop 0
    buffer_load_dwordx4 v4, s[72:75], s76 offen offset:1024 nt lds
    v_and_b32 v85, 0xffff0000, v108
    s_waitcnt vmcnt(21)
    v_mfma_f32_16x16x32_bf16 v[40:43], a[220:223], v[20:23], v[40:43]
    v_lshlrev_b32 v86, 16, v109
    v_and_b32 v87, 0xffff0000, v109
    v_mfma_f32_16x16x32_bf16 v[44:47], a[200:203], v[16:19], v[44:47]
    v_lshlrev_b32 v88, 16, v110
    s_waitcnt vmcnt(20)
    v_mfma_f32_16x16x32_bf16 v[44:47], a[224:227], v[20:23], v[44:47]
    v_and_b32 v89, 0xffff0000, v110
    v_lshlrev_b32 v90, 16, v111
    v_mfma_f32_16x16x32_bf16 v[48:51], a[204:207], v[16:19], v[48:51]
    v_and_b32 v91, 0xffff0000, v111
    s_waitcnt vmcnt(19)
    v_mfma_f32_16x16x32_bf16 v[48:51], a[228:231], v[20:23], v[48:51]
    s_add_u32 m0, s77, 3072
    s_nop 0
    buffer_load_dwordx4 v5, s[72:75], s76 offen offset:2048 nt lds
    v_lshlrev_b32 v92, 16, v112
    v_mfma_f32_16x16x32_bf16 v[52:55], a[208:211], v[16:19], v[52:55]
    v_and_b32 v93, 0xffff0000, v112
    v_lshlrev_b32 v94, 16, v113
    s_waitcnt vmcnt(19)
    v_mfma_f32_16x16x32_bf16 v[52:55], a[232:235], v[20:23], v[52:55]
    v_and_b32 v95, 0xffff0000, v113
    v_mfma_f32_16x16x32_bf16 v[56:59], a[212:215], v[16:19], v[56:59]
    v_lshlrev_b32 v96, 16, v114
    v_and_b32 v97, 0xffff0000, v114
    s_waitcnt vmcnt(18)
    v_mfma_f32_16x16x32_bf16 v[56:59], a[236:239], v[20:23], v[56:59]
    v_lshlrev_b32 v98, 16, v115
    s_waitcnt lgkmcnt(1)
    s_waitcnt vmcnt(17)
    v_mfma_f32_16x16x32_bf16 v[36:39], a[240:243], v[24:27], v[36:39]
    ds_read_b128 v[16:19], v6 offset:768
    s_waitcnt lgkmcnt(1)
    s_waitcnt vmcnt(11)
    v_mfma_f32_16x16x32_bf16 v[36:39], v[232:235], v[28:31], v[36:39]
    ds_read_b128 v[20:23], v7 offset:768
    v_mfma_f32_16x16x32_bf16 v[40:43], a[244:247], v[24:27], v[40:43]
    v_and_b32 v99, 0xffff0000, v115
    s_waitcnt vmcnt(10)
    v_mfma_f32_16x16x32_bf16 v[40:43], v[236:239], v[28:31], v[40:43]
    v_lshlrev_b32 v100, 16, v116
    v_mfma_f32_16x16x32_bf16 v[44:47], a[248:251], v[24:27], v[44:47]
    v_and_b32 v101, 0xffff0000, v116
    s_waitcnt vmcnt(9)
    v_mfma_f32_16x16x32_bf16 v[44:47], v[240:243], v[28:31], v[44:47]
    v_lshlrev_b32 v102, 16, v117
    v_mfma_f32_16x16x32_bf16 v[48:51], a[252:255], v[24:27], v[48:51]
    v_and_b32 v103, 0xffff0000, v117
    s_waitcnt vmcnt(8)
    v_mfma_f32_16x16x32_bf16 v[48:51], v[244:247], v[28:31], v[48:51]
    v_lshlrev_b32 v104, 16, v118
    v_mfma_f32_16x16x32_bf16 v[52:55], v[224:227], v[24:27], v[52:55]
    v_and_b32 v105, 0xffff0000, v118
    s_waitcnt vmcnt(7)
    v_mfma_f32_16x16x32_bf16 v[52:55], v[248:251], v[28:31], v[52:55]
    v_lshlrev_b32 v106, 16, v119
    v_mfma_f32_16x16x32_bf16 v[56:59], v[228:231], v[24:27], v[56:59]
    v_and_b32 v107, 0xffff0000, v119
    s_waitcnt vmcnt(6)
    v_mfma_f32_16x16x32_bf16 v[56:59], v[252:255], v[28:31], v[56:59]
    s_nop 3
    v_add_f32 v36, v36, v84
    v_add_f32 v37, v37, v85
    v_add_f32 v38, v38, v86
    v_add_f32 v39, v39, v87
    v_add_f32 v40, v40, v88
    v_add_f32 v41, v41, v89
    v_add_f32 v42, v42, v90
    v_add_f32 v43, v43, v91
    v_add_f32 v44, v44, v92
    v_add_f32 v45, v45, v93
    v_add_f32 v46, v46, v94
    v_add_f32 v47, v47, v95
    v_add_f32 v48, v48, v96
    v_add_f32 v49, v49, v97
    v_add_f32 v50, v50, v98
    v_add_f32 v51, v51, v99
    v_add_f32 v52, v52, v100
    v_add_f32 v53, v53, v101
    v_add_f32 v54, v54, v102
    v_add_f32 v55, v55, v103
    v_add_f32 v56, v56, v104
    v_add_f32 v57, v57, v105
    v_add_f32 v58, v58, v106
    v_add_f32 v59, v59, v107
    s_mov_b64 vcc, 0
    s_branch L_g1
L_top:
    s_waitcnt lgkmcnt(1)
    v_mfma_f32_16x16x32_bf16 v[36:39], a[0:3], v[16:19], v[84:87]
    ds_read_b128 v[24:27], v8 offset:0
    s_waitcnt lgkmcnt(1)
    v_mfma_f32_16x16x32_bf16 v[36:39], a[24:27], v[20:23], v[36:39]
    ds_read_b128 v[28:31], v9 offset:0
    v_mfma_f32_16x16x32_bf16 v[40:43], a[4:7], v[16:19], v[88:91]
    s_add_u32 m0, s56, 3072
    s_nop 0
    buffer_load_dwordx4 v3, s[8:11], s54 offen offset:0 nt lds
    v_mfma_f32_16x16x32_bf16 v[40:43], a[28:31], v[20:23], v[40:43]
    v_mfma_f32_16x16x32_bf16 v[44:47], a[8:11], v[16:19], v[92:95]
    v_cvt_pk_bf16_f32 v76, v76, v77
    v_mfma_f32_16x16x32_bf16 v[44:47], a[32:35], v[20:23], v[44:47]
    v_mfma_f32_16x16x32_bf16 v[48:51], a[12:15], v[16:19], v[96:99]
    v_cvt_pk_bf16_f32 v77, v78, v79
    v_mfma_f32_16x16x32_bf16 v[48:51], a[36:39], v[20:23], v[48:51]
    v_mfma_f32_16x16x32_bf16 v[52:55], a[16:19], v[16:19], v[100:103]
    v_cvt_pk_bf16_f32 v78, v80, v81
    v_mfma_f32_16x16x32_bf16 v[52:55], a[40:43], v[20:23], v[52:55]
    v_mfma_f32_16x16x32_bf16 v[56:59], a[20:23], v[16:19], v[104:107]
    v_cvt_pk_bf16_f32 v79, v82, v83
    v_mfma_f32_16x16x32_bf16 v[56:59], a[44:47], v[20:23], v[56:59]
    s_waitcnt lgkmcnt(1)
    v_mfma_f32_16x16x32_bf16 v[36:39], a[48:51], v[24:27], v[36:39]
    ds_read_b128 v[16:19], v6 offset:256
    s_waitcnt lgkmcnt(1)
    v_mfma_f32_16x16x32_bf16 v[36:39], a[72:75], v[28:31], v[36:39]
    ds_read_b128 v[20:23], v7 offset:256
    v_mfma_f32_16x16x32_bf16 v[40:43], a[52:55], v[24:27], v[40:43]
    ds_write_b128 v10, v[76:79] offset:12288
    v_cvt_pk_bf16_f32 v60, v60, v61
    v_mfma_f32_16x16x32_bf16 v[40:43], a[76:79], v[28:31], v[40:43]
    v_cvt_pk_bf16_f32 v61, v62, v63
    v_mfma_f32_16x16x32_bf16 v[44:47], a[56:59], v[24:27], v[44:47]
    v_cvt_pk_bf16_f32 v62, v64, v65
    v_mfma_f32_16x16x32_bf16 v[44:47], a[80:83], v[28:31], v[44:47]
    v_cvt_pk_bf16_f32 v63, v66, v67
    v_cvt_pk_bf16_f32 v68, v68, v69
    v_mfma_f32_16x16x32_bf16 v[48:51], a[60:63], v[24:27], v[48:51]
    v_cvt_pk_bf16_f32 v69, v70, v71
    v_mfma_f32_16x16x32_bf16 v[48:51], a[84:87], v[28:31], v[48:51]
    v_cvt_pk_bf16_f32 v70, v72, v73
    v_mfma_f32_16x16x32_bf16 v[52:55], a[64:67], v[24:27], v[52:55]
    v_cvt_pk_bf16_f32 v71, v74, v75
    v_mov_b32 v64, v60
    v_mfma_f32_16x16x32_bf16 v[52:55], a[88:91], v[28:31], v[52:55]
    v_mov_b32 v65, v61
    v_mfma_f32_16x16x32_bf16 v[56:59], a[68:71], v[24:27], v[56:59]
    v_mov_b32 v66, v62
    v_mfma_f32_16x16x32_bf16 v[56:59], a[92:95], v[28:31], v[56:59]
    v_mov_b32 v67, v63
    s_waitcnt lgkmcnt(2)
    v_mfma_f32_16x16x32_bf16 v[36:39], a[96:99], v[16:19], v[36:39]
    ds_read_b128 v[24:27], v8 offset:256
    s_waitcnt lgkmcnt(2)
    v_mfma_f32_16x16x32_bf16 v[36:39], a[120:123], v[20:23], v[36:39]
    ds_read_b128 v[28:31], v9 offset:256
    v_mfma_f32_16x16x32_bf16 v[40:43], a[100:103], v[16:19], v[40:43]
    v_mov_b32_dpp v60, v68 row_ror:8 row_mask:0xf bank_mask:0xc
    v_mfma_f32_16x16x32_bf16 v[40:43], a[124:127], v[20:23], v[40:43]
    v_mov_b32_dpp v61, v69 row_ror:8 row_mask:0xf bank_mask:0xc
    v_mfma_f32_16x16x32_bf16 v[44:47], a[104:107], v[16:19], v[44:47]
    v_mov_b32_dpp v62, v70 row_ror:8 row_mask:0xf bank_mask:0xc
    v_mfma_f32_16x16x32_bf16 v[44:47], a[128:131], v[20:23], v[44:47]
    v_mov_b32_dpp v63, v71 row_ror:8 row_mask:0xf bank_mask:0xc
    v_mfma_f32_16x16x32_bf16 v[48:51], a[108:111], v[16:19], v[48:51]
    v_mov_b32_dpp v68, v64 row_ror:8 row_mask:0xf bank_mask:0x3
    v_mfma_f32_16x16x32_bf16 v[48:51], a[132:135], v[20:23], v[48:51]
    v_mov_b32_dpp v69, v65 row_ror:8 row_mask:0xf bank_mask:0x3
    v_mfma_f32_16x16x32_bf16 v[52:55], a[112:115], v[16:19], v[52:55]
    v_mov_b32_dpp v70, v66 row_ror:8 row_mask:0xf bank_mask:0x3
    v_mfma_f32_16x16x32_bf16 v[52:55], a[136:139], v[20:23], v[52:55]
    v_mov_b32_dpp v71, v67 row_ror:8 row_mask:0xf bank_mask:0x3
    v_mfma_f32_16x16x32_bf16 v[56:59], a[116:119], v[16:19], v[56:59]
    buffer_store_dwordx4 v[60:63], v12, s[20:23], s47 offen offset:768 sc1
    v_mfma_f32_16x16x32_bf16 v[56:59], a[140:143], v[20:23], v[56:59]
    s_waitcnt lgkmcnt(1)
    v_mfma_f32_16x16x32_bf16 v[36:39], a[144:147], v[24:27], v[36:39]
    ds_read_b128 v[16:19], v6 offset:512
    s_waitcnt lgkmcnt(1)
    v_mfma_f32_16x16x32_bf16 v[36:39], a[168:171], v[28:31], v[36:39]
    ds_read_b128 v[20:23], v7 offset:512
    v_mfma_f32_16x16x32_bf16 v[40:43], a[148:151], v[24:27], v[40:43]
    s_add_u32 m0, s56, 3072
    s_nop 0
    buffer_load_dwordx4 v4, s[8:11], s54 offen offset:1024 nt lds
    v_mfma_f32_16x16x32_bf16 v[40:43], a[172:175], v[28:31], v[40:43]
    v_mfma_f32_16x16x32_bf16 v[44:47], a[152:155], v[24:27], v[44:47]
    v_mfma_f32_16x16x32_bf16 v[44:47], a[176:179], v[28:31], v[44:47]
    v_mfma_f32_16x16x32_bf16 v[48:51], a[156:159], v[24:27], v[48:51]
    v_mfma_f32_16x16x32_bf16 v[48:51], a[180:183], v[28:31], v[48:51]
    v_mfma_f32_16x16x32_bf16 v[52:55], a[160:163], v[24:27], v[52:55]
    v_mfma_f32_16x16x32_bf16 v[52:55], a[184:187], v[28:31], v[52:55]
    v_mfma_f32_16x16x32_bf16 v[56:59], a[164:167], v[24:27], v[56:59]
    v_mfma_f32_16x16x32_bf16 v[56:59], a[188:191], v[28:31], v[56:59]
    s_waitcnt lgkmcnt(1)
    v_mfma_f32_16x16x32_bf16 v[36:39], a[192:195], v[16:19], v[36:39]
    ds_read_b128 v[24:27], v8 offset:512
    s_waitcnt lgkmcnt(1)
    v_mfma_f32_16x16x32_bf16 v[36:39], a[216:219], v[20:23], v[36:39]
    ds_read_b128 v[28:31], v9 offset:512
    v_mfma_f32_16x16x32_bf16 v[40:43], a[196:199], v[16:19], v[40:43]
    buffer_store_dwordx4 v[68:71], v13, s[20:23], s47 offen offset:768 sc1
    v_mfma_f32_16x16x32_bf16 v[40:43], a[220:223], v[20:23], v[40:43]
    v_mfma_f32_16x16x32_bf16 v[44:47], a[200:203], v[16:19], v[44:47]
    v_mfma_f32_16x16x32_bf16 v[44:47], a[224:227], v[20:23], v[44:47]
    s_mov_b32 s50, s51
    s_mov_b32 s51, s52
    v_mfma_f32_16x16x32_bf16 v[48:51], a[204:207], v[16:19], v[48:51]
    v_mfma_f32_16x16x32_bf16 v[48:51], a[228:231], v[20:23], v[48:51]
    v_mfma_f32_16x16x32_bf16 v[52:55], a[208:211], v[16:19], v[52:55]
    s_add_u32 s58, s58, 1
    s_cmp_eq_u32 s58, 3
    s_cselect_b32 s58, 0, s58
    v_mfma_f32_16x16x32_bf16 v[52:55], a[232:235], v[20:23], v[52:55]
    v_mfma_f32_16x16x32_bf16 v[56:59], a[212:215], v[16:19], v[56:59]
    v_mfma_f32_16x16x32_bf16 v[56:59], a[236:239], v[20:23], v[56:59]
    s_waitcnt lgkmcnt(1)
    v_mfma_f32_16x16x32_bf16 v[36:39], a[240:243], v[24:27], v[36:39]
    ds_read_b128 v[16:19], v6 offset:768
    s_waitcnt lgkmcnt(1)
    v_mfma_f32_16x16x32_bf16 v[36:39], v[232:235], v[28:31], v[36:39]
    ds_read_b128 v[20:23], v7 offset:768
    v_mfma_f32_16x16x32_bf16 v[40:43], a[244:247], v[24:27], v[40:43]
    s_add_u32 m0, s56, 3072
    s_nop 0
    buffer_load_dwordx4 v5, s[8:11], s54 offen offset:2048 nt lds
    v_mfma_f32_16x16x32_bf16 v[40:43], v[236:239], v[28:31], v[40:43]
    v_mfma_f32_16x16x32_bf16 v[44:47], a[248:251], v[24:27], v[44:47]
    v_mfma_f32_16x16x32_bf16 v[44:47], v[240:243], v[28:31], v[44:47]
    s_cmp_eq_u32 s58, 2
    s_cselect_b32 s57, -147456, 0
    s_add_u32 s57, s57, 49152
    v_mfma_f32_16x16x32_bf16 v[48:51], a[252:255], v[24:27], v[48:51]
    v_mfma_f32_16x16x32_bf16 v[48:51], v[244:247], v[28:31], v[48:51]
    v_mfma_f32_16x16x32_bf16 v[52:55], v[224:227], v[24:27], v[52:55]
    s_add_u32 s59, s59, 12
    v_mfma_f32_16x16x32_bf16 v[52:55], v[248:251], v[28:31], v[52:55]
    v_mfma_f32_16x16x32_bf16 v[56:59], v[228:231], v[24:27], v[56:59]
    v_mfma_f32_16x16x32_bf16 v[56:59], v[252:255], v[28:31], v[56:59]
L_g1:
    s_waitcnt lgkmcnt(1)
    v_mfma_f32_16x16x32_bf16 v[60:63], a[0:3], v[16:19], v[84:87]
    ds_read_b128 v[24:27], v8 offset:768
    s_waitcnt lgkmcnt(1)
    v_mfma_f32_16x16x32_bf16 v[60:63], a[24:27], v[20:23], v[60:63]
    ds_read_b128 v[28:31], v9 offset:768
    v_mfma_f32_16x16x32_bf16 v[64:67], a[4:7], v[16:19], v[88:91]
    v_cvt_pk_bf16_f32 v52, v52, v53
    v_mfma_f32_16x16x32_bf16 v[64:67], a[28:31], v[20:23], v[64:67]
    v_mfma_f32_16x16x32_bf16 v[68:71], a[8:11], v[16:19], v[92:95]
    v_cvt_pk_bf16_f32 v53, v54, v55
    v_mfma_f32_16x16x32_bf16 v[68:71], a[32:35], v[20:23], v[68:71]
    v_mfma_f32_16x16x32_bf16 v[72:75], a[12:15], v[16:19], v[96:99]
    v_mfma_f32_16x16x32_bf16 v[72:75], a[36:39], v[20:23], v[72:75]
    v_cvt_pk_bf16_f32 v54, v56, v57
    v_mfma_f32_16x16x32_bf16 v[76:79], a[16:19], v[16:19], v[100:103]
    v_mfma_f32_16x16x32_bf16 v[76:79], a[40:43], v[20:23], v[76:79]
    v_cvt_pk_bf16_f32 v55, v58, v59
    v_mfma_f32_16x16x32_bf16 v[80:83], a[20:23], v[16:19], v[104:107]
    v_mfma_f32_16x16x32_bf16 v[80:83], a[44:47], v[20:23], v[80:83]
    s_waitcnt lgkmcnt(1)
    v_mfma_f32_16x16x32_bf16 v[60:63], a[48:51], v[24:27], v[60:63]
    ds_read_b128 v[16:19], v6 offset:1024
    s_waitcnt lgkmcnt(1)
    v_mfma_f32_16x16x32_bf16 v[60:63], a[72:75], v[28:31], v[60:63]
    ds_read_b128 v[20:23], v7 offset:1024
    v_mfma_f32_16x16x32_bf16 v[64:67], a[52:55], v[24:27], v[64:67]
    ds_write_b128 v10, v[52:55] offset:0
    v_cvt_pk_bf16_f32 v36, v36, v37
    v_mfma_f32_16x16x32_bf16 v[64:67], a[76:79], v[28:31], v[64:67]
    v_cvt_pk_bf16_f32 v37, v38, v39
    v_mfma_f32_16x16x32_bf16 v[68:71], a[56:59], v[24:27], v[68:71]
    v_cvt_pk_bf16_f32 v38, v40, v41
    v_mfma_f32_16x16x32_bf16 v[68:71], a[80:83], v[28:31], v[68:71]
    v_cvt_pk_bf16_f32 v39, v42, v43
    v_cvt_pk_bf16_f32 v44, v44, v45
    v_mfma_f32_16x16x32_bf16 v[72:75], a[60:63], v[24:27], v[72:75]
    v_cvt_pk_bf16_f32 v45, v46, v47
    v_mfma_f32_16x16x32_bf16 v[72:75], a[84:87], v[28:31], v[72:75]
    v_cvt_pk_bf16_f32 v46, v48, v49
    v_mfma_f32_16x16x32_bf16 v[76:79], a[64:67], v[24:27], v[76:79]
    v_cvt_pk_bf16_f32 v47, v50, v51
    v_mov_b32 v40, v36
    v_mfma_f32_16x16x32_bf16 v[76:79], a[88:91], v[28:31], v[76:79]
    v_mov_b32 v41, v37
    v_mfma_f32_16x16x32_bf16 v[80:83], a[68:71], v[24:27], v[80:83]
    v_mov_b32 v42, v38
    v_mfma_f32_16x16x32_bf16 v[80:83], a[92:95], v[28:31], v[80:83]
    v_mov_b32 v43, v39
    s_waitcnt lgkmcnt(2)
    s_waitcnt vmcnt(12)
    s_waitcnt lgkmcnt(0)
    s_barrier
    v_mfma_f32_16x16x32_bf16 v[60:63], a[96:99], v[16:19], v[60:63]
    ds_read_b128 v[24:27], v8 offset:1024
    v_mfma_f32_16x16x32_bf16 v[60:63], a[120:123], v[20:23], v[60:63]
    ds_read_b128 v[28:31], v9 offset:1024
    v_mfma_f32_16x16x32_bf16 v[64:67], a[100:103], v[16:19], v[64:67]
    v_mov_b32_dpp v36, v44 row_ror:8 row_mask:0xf bank_mask:0xc
    v_mov_b32_dpp v37, v45 row_ror:8 row_mask:0xf bank_mask:0xc
    v_mfma_f32_16x16x32_bf16 v[64:67], a[124:127], v[20:23], v[64:67]
    v_mov_b32_dpp v38, v46 row_ror:8 row_mask:0xf bank_mask:0xc
    v_mfma_f32_16x16x32_bf16 v[68:71], a[104:107], v[16:19], v[68:71]
    v_mov_b32_dpp v39, v47 row_ror:8 row_mask:0xf bank_mask:0xc
    v_mfma_f32_16x16x32_bf16 v[68:71], a[128:131], v[20:23], v[68:71]
    ds_read_b128 v[48:51], v11 offset:12288
    v_mfma_f32_16x16x32_bf16 v[72:75], a[108:111], v[16:19], v[72:75]
    ds_read_b128 v[56:59], v11 offset:0
    v_mfma_f32_16x16x32_bf16 v[72:75], a[132:135], v[20:23], v[72:75]
    v_mov_b32_dpp v44, v40 row_ror:8 row_mask:0xf bank_mask:0x3
    v_mfma_f32_16x16x32_bf16 v[76:79], a[112:115], v[16:19], v[76:79]
    v_mov_b32_dpp v45, v41 row_ror:8 row_mask:0xf bank_mask:0x3
    v_mfma_f32_16x16x32_bf16 v[76:79], a[136:139], v[20:23], v[76:79]
    v_mov_b32_dpp v46, v42 row_ror:8 row_mask:0xf bank_mask:0x3
    v_mfma_f32_16x16x32_bf16 v[80:83], a[116:119], v[16:19], v[80:83]
    v_mov_b32_dpp v47, v43 row_ror:8 row_mask:0xf bank_mask:0x3
    v_mfma_f32_16x16x32_bf16 v[80:83], a[140:143], v[20:23], v[80:83]
    buffer_store_dwordx4 v[36:39], v12, s[20:23], s48 offen offset:0 sc1
    s_waitcnt lgkmcnt(3)
    v_mfma_f32_16x16x32_bf16 v[60:63], a[144:147], v[24:27], v[60:63]
    ds_read_b128 v[16:19], v6 offset:1280
    s_waitcnt lgkmcnt(3)
    v_mfma_f32_16x16x32_bf16 v[60:63], a[168:171], v[28:31], v[60:63]
    ds_read_b128 v[20:23], v7 offset:1280
    v_mfma_f32_16x16x32_bf16 v[64:67], a[148:151], v[24:27], v[64:67]
    s_add_u32 m0, s56, 24576
    s_nop 0
    buffer_load_dwordx4 v0, s[8:11], s55 offen offset:0 nt lds
    v_mfma_f32_16x16x32_bf16 v[64:67], a[172:175], v[28:31], v[64:67]
    v_mfma_f32_16x16x32_bf16 v[68:71], a[152:155], v[24:27], v[68:71]
    v_mfma_f32_16x16x32_bf16 v[68:71], a[176:179], v[28:31], v[68:71]
    v_mfma_f32_16x16x32_bf16 v[72:75], a[156:159], v[24:27], v[72:75]
    v_mfma_f32_16x16x32_bf16 v[72:75], a[180:183], v[28:31], v[72:75]
    buffer_store_dwordx4 v[44:47], v13, s[20:23], s48 offen offset:0 sc1
    v_mfma_f32_16x16x32_bf16 v[76:79], a[160:163], v[24:27], v[76:79]
    v_mfma_f32_16x16x32_bf16 v[76:79], a[184:187], v[28:31], v[76:79]
    v_mfma_f32_16x16x32_bf16 v[80:83], a[164:167], v[24:27], v[80:83]
    v_mfma_f32_16x16x32_bf16 v[80:83], a[188:191], v[28:31], v[80:83]
    s_waitcnt lgkmcnt(1)
    v_mfma_f32_16x16x32_bf16 v[60:63], a[192:195], v[16:19], v[60:63]
    ds_read_b128 v[24:27], v8 offset:1280
    s_waitcnt lgkmcnt(1)
    v_mfma_f32_16x16x32_bf16 v[60:63], a[216:219], v[20:23], v[60:63]
    ds_read_b128 v[28:31], v9 offset:1280
    v_mfma_f32_16x16x32_bf16 v[64:67], a[196:199], v[16:19], v[64:67]
    buffer_store_dwordx4 v[48:51], v14, s[20:23], s47 offen offset:768 sc1
    v_mfma_f32_16x16x32_bf16 v[64:67], a[220:223], v[20:23], v[64:67]
    v_mfma_f32_16x16x32_bf16 v[68:71], a[200:203], v[16:19], v[68:71]
    v_mfma_f32_16x16x32_bf16 v[68:71], a[224:227], v[20:23], v[68:71]
    v_mfma_f32_16x16x32_bf16 v[72:75], a[204:207], v[16:19], v[72:75]
    v_mfma_f32_16x16x32_bf16 v[72:75], a[228:231], v[20:23], v[72:75]
    s_add_u32 m0, s56, 24576
    s_nop 0
    buffer_load_dwordx4 v1, s[8:11], s55 offen offset:1024 nt lds
    v_mfma_f32_16x16x32_bf16 v[76:79], a[208:211], v[16:19], v[76:79]
    v_mfma_f32_16x16x32_bf16 v[76:79], a[232:235], v[20:23], v[76:79]
    v_mfma_f32_16x16x32_bf16 v[80:83], a[212:215], v[16:19], v[80:83]
    v_mfma_f32_16x16x32_bf16 v[80:83], a[236:239], v[20:23], v[80:83]
    s_waitcnt lgkmcnt(1)
    v_mfma_f32_16x16x32_bf16 v[60:63], a[240:243], v[24:27], v[60:63]
    ds_read_b128 v[16:19], v6 offset:24576
    s_waitcnt lgkmcnt(1)
    v_mfma_f32_16x16x32_bf16 v[60:63], v[232:235], v[28:31], v[60:63]
    ds_read_b128 v[20:23], v7 offset:24576
    v_mfma_f32_16x16x32_bf16 v[64:67], a[244:247], v[24:27], v[64:67]
    buffer_store_dwordx4 v[56:59], v14, s[20:23], s48 offen offset:0 sc1
    v_mfma_f32_16x16x32_bf16 v[64:67], v[236:239], v[28:31], v[64:67]
    v_mfma_f32_16x16x32_bf16 v[68:71], a[248:251], v[24:27], v[68:71]
    v_mfma_f32_16x16x32_bf16 v[68:71], v[240:243], v[28:31], v[68:71]
    v_mfma_f32_16x16x32_bf16 v[72:75], a[252:255], v[24:27], v[72:75]
    v_mfma_f32_16x16x32_bf16 v[72:75], v[244:247], v[28:31], v[72:75]
    s_add_u32 m0, s56, 24576
    s_nop 0
    buffer_load_dwordx4 v2, s[8:11], s55 offen offset:2048 nt lds
    v_mfma_f32_16x16x32_bf16 v[76:79], v[224:227], v[24:27], v[76:79]
    v_mfma_f32_16x16x32_bf16 v[76:79], v[248:251], v[28:31], v[76:79]
    v_mfma_f32_16x16x32_bf16 v[80:83], v[228:231], v[24:27], v[80:83]
    v_mfma_f32_16x16x32_bf16 v[80:83], v[252:255], v[28:31], v[80:83]
    s_waitcnt lgkmcnt(1)
    v_mfma_f32_16x16x32_bf16 v[36:39], a[0:3], v[16:19], v[84:87]
    ds_read_b128 v[24:27], v8 offset:24576
    s_waitcnt lgkmcnt(1)
    v_mfma_f32_16x16x32_bf16 v[36:39], a[24:27], v[20:23], v[36:39]
    ds_read_b128 v[28:31], v9 offset:24576
    v_mfma_f32_16x16x32_bf16 v[40:43], a[4:7], v[16:19], v[88:91]
    s_add_u32 m0, s56, 27648
    s_nop 0
    buffer_load_dwordx4 v3, s[8:11], s55 offen offset:0 nt lds
    v_mfma_f32_16x16x32_bf16 v[40:43], a[28:31], v[20:23], v[40:43]
    v_mfma_f32_16x16x32_bf16 v[44:47], a[8:11], v[16:19], v[92:95]
    v_cvt_pk_bf16_f32 v76, v76, v77
    v_mfma_f32_16x16x32_bf16 v[44:47], a[32:35], v[20:23], v[44:47]
    v_mfma_f32_16x16x32_bf16 v[48:51], a[12:15], v[16:19], v[96:99]
    v_cvt_pk_bf16_f32 v77, v78, v79
    v_mfma_f32_16x16x32_bf16 v[48:51], a[36:39], v[20:23], v[48:51]
    v_mfma_f32_16x16x32_bf16 v[52:55], a[16:19], v[16:19], v[100:103]
    v_cvt_pk_bf16_f32 v78, v80, v81
    v_mfma_f32_16x16x32_bf16 v[52:55], a[40:43], v[20:23], v[52:55]
    v_mfma_f32_16x16x32_bf16 v[56:59], a[20:23], v[16:19], v[104:107]
    v_cvt_pk_bf16_f32 v79, v82, v83
    v_mfma_f32_16x16x32_bf16 v[56:59], a[44:47], v[20:23], v[56:59]
    s_waitcnt lgkmcnt(1)
    v_mfma_f32_16x16x32_bf16 v[36:39], a[48:51], v[24:27], v[36:39]
    ds_read_b128 v[16:19], v6 offset:24832
    s_waitcnt lgkmcnt(1)
    v_mfma_f32_16x16x32_bf16 v[36:39], a[72:75], v[28:31], v[36:39]
    ds_read_b128 v[20:23], v7 offset:24832
    v_mfma_f32_16x16x32_bf16 v[40:43], a[52:55], v[24:27], v[40:43]
    ds_write_b128 v10, v[76:79] offset:4096
    v_cvt_pk_bf16_f32 v60, v60, v61
    v_mfma_f32_16x16x32_bf16 v[40:43], a[76:79], v[28:31], v[40:43]
    v_cvt_pk_bf16_f32 v61, v62, v63
    v_mfma_f32_16x16x32_bf16 v[44:47], a[56:59], v[24:27], v[44:47]
    v_cvt_pk_bf16_f32 v62, v64, v65
    v_mfma_f32_16x16x32_bf16 v[44:47], a[80:83], v[28:31], v[44:47]
    v_cvt_pk_bf16_f32 v63, v66, v67
    v_cvt_pk_bf16_f32 v68, v68, v69
    v_mfma_f32_16x16x32_bf16 v[48:51], a[60:63], v[24:27], v[48:51]
    v_cvt_pk_bf16_f32 v69, v70, v71
    v_mfma_f32_16x16x32_bf16 v[48:51], a[84:87], v[28:31], v[48:51]
    v_cvt_pk_bf16_f32 v70, v72, v73
    v_mfma_f32_16x16x32_bf16 v[52:55], a[64:67], v[24:27], v[52:55]
    v_cvt_pk_bf16_f32 v71, v74, v75
    v_mov_b32 v64, v60
    v_mfma_f32_16x16x32_bf16 v[52:55], a[88:91], v[28:31], v[52:55]
    v_mov_b32 v65, v61
    v_mfma_f32_16x16x32_bf16 v[56:59], a[68:71], v[24:27], v[56:59]
    v_mov_b32 v66, v62
    v_mfma_f32_16x16x32_bf16 v[56:59], a[92:95], v[28:31], v[56:59]
    v_mov_b32 v67, v63
    s_waitcnt lgkmcnt(2)
    v_mfma_f32_16x16x32_bf16 v[36:39], a[96:99], v[16:19], v[36:39]
    ds_read_b128 v[24:27], v8 offset:24832
    s_waitcnt lgkmcnt(2)
    v_mfma_f32_16x16x32_bf16 v[36:39], a[120:123], v[20:23], v[36:39]
    ds_read_b128 v[28:31], v9 offset:24832
    v_mfma_f32_16x16x32_bf16 v[40:43], a[100:103], v[16:19], v[40:43]
    v_mov_b32_dpp v60, v68 row_ror:8 row_mask:0xf bank_mask:0xc
    v_mfma_f32_16x16x32_bf16 v[40:43], a[124:127], v[20:23], v[40:43]
    v_mov_b32_dpp v61, v69 row_ror:8 row_mask:0xf bank_mask:0xc
    v_mfma_f32_16x16x32_bf16 v[44:47], a[104:107], v[16:19], v[44:47]
    v_mov_b32_dpp v62, v70 row_ror:8 row_mask:0xf bank_mask:0xc
    v_mfma_f32_16x16x32_bf16 v[44:47], a[128:131], v[20:23], v[44:47]
    v_mov_b32_dpp v63, v71 row_ror:8 row_mask:0xf bank_mask:0xc
    v_mfma_f32_16x16x32_bf16 v[48:51], a[108:111], v[16:19], v[48:51]
    v_mov_b32_dpp v68, v64 row_ror:8 row_mask:0xf bank_mask:0x3
    v_mfma_f32_16x16x32_bf16 v[48:51], a[132:135], v[20:23], v[48:51]
    v_mov_b32_dpp v69, v65 row_ror:8 row_mask:0xf bank_mask:0x3
    v_mfma_f32_16x16x32_bf16 v[52:55], a[112:115], v[16:19], v[52:55]
    v_mov_b32_dpp v70, v66 row_ror:8 row_mask:0xf bank_mask:0x3
    v_mfma_f32_16x16x32_bf16 v[52:55], a[136:139], v[20:23], v[52:55]
    v_mov_b32_dpp v71, v67 row_ror:8 row_mask:0xf bank_mask:0x3
    v_mfma_f32_16x16x32_bf16 v[56:59], a[116:119], v[16:19], v[56:59]
    buffer_store_dwordx4 v[60:63], v12, s[20:23], s48 offen offset:768 sc1
    v_mfma_f32_16x16x32_bf16 v[56:59], a[140:143], v[20:23], v[56:59]
    s_waitcnt lgkmcnt(1)
    v_mfma_f32_16x16x32_bf16 v[36:39], a[144:147], v[24:27], v[36:39]
    ds_read_b128 v[16:19], v6 offset:25088
    s_waitcnt lgkmcnt(1)
    v_mfma_f32_16x16x32_bf16 v[36:39], a[168:171], v[28:31], v[36:39]
    ds_read_b128 v[20:23], v7 offset:25088
    v_mfma_f32_16x16x32_bf16 v[40:43], a[148:151], v[24:27], v[40:43]
    s_add_u32 m0, s56, 27648
    s_nop 0
    buffer_load_dwordx4 v4, s[8:11], s55 offen offset:1024 nt lds
    v_mfma_f32_16x16x32_bf16 v[40:43], a[172:175], v[28:31], v[40:43]
    v_mfma_f32_16x16x32_bf16 v[44:47], a[152:155], v[24:27], v[44:47]
    v_mfma_f32_16x16x32_bf16 v[44:47], a[176:179], v[28:31], v[44:47]
    v_mfma_f32_16x16x32_bf16 v[48:51], a[156:159], v[24:27], v[48:51]
    v_mfma_f32_16x16x32_bf16 v[48:51], a[180:183], v[28:31], v[48:51]
    v_mfma_f32_16x16x32_bf16 v[52:55], a[160:163], v[24:27], v[52:55]
    v_mfma_f32_16x16x32_bf16 v[52:55], a[184:187], v[28:31], v[52:55]
    v_mfma_f32_16x16x32_bf16 v[56:59], a[164:167], v[24:27], v[56:59]
    v_mfma_f32_16x16x32_bf16 v[56:59], a[188:191], v[28:31], v[56:59]
    s_waitcnt lgkmcnt(1)
    v_mfma_f32_16x16x32_bf16 v[36:39], a[192:195], v[16:19], v[36:39]
    ds_read_b128 v[24:27], v8 offset:25088
    s_waitcnt lgkmcnt(1)
    v_mfma_f32_16x16x32_bf16 v[36:39], a[216:219], v[20:23], v[36:39]
    ds_read_b128 v[28:31], v9 offset:25088
    v_mfma_f32_16x16x32_bf16 v[40:43], a[196:199], v[16:19], v[40:43]
    buffer_store_dwordx4 v[68:71], v13, s[20:23], s48 offen offset:768 sc1
    v_mfma_f32_16x16x32_bf16 v[40:43], a[220:223], v[20:23], v[40:43]
    v_mfma_f32_16x16x32_bf16 v[44:47], a[200:203], v[16:19], v[44:47]
    v_mfma_f32_16x16x32_bf16 v[44:47], a[224:227], v[20:23], v[44:47]
    v_mfma_f32_16x16x32_bf16 v[48:51], a[204:207], v[16:19], v[48:51]
    v_mfma_f32_16x16x32_bf16 v[48:51], a[228:231], v[20:23], v[48:51]
    v_mfma_f32_16x16x32_bf16 v[52:55], a[208:211], v[16:19], v[52:55]
    v_mfma_f32_16x16x32_bf16 v[52:55], a[232:235], v[20:23], v[52:55]
    v_mfma_f32_16x16x32_bf16 v[56:59], a[212:215], v[16:19], v[56:59]
    v_mfma_f32_16x16x32_bf16 v[56:59], a[236:239], v[20:23], v[56:59]
    s_waitcnt lgkmcnt(1)
    v_mfma_f32_16x16x32_bf16 v[36:39], a[240:243], v[24:27], v[36:39]
    ds_read_b128 v[16:19], v6 offset:25344
    s_waitcnt lgkmcnt(1)
    v_mfma_f32_16x16x32_bf16 v[36:39], v[232:235], v[28:31], v[36:39]
    ds_read_b128 v[20:23], v7 offset:25344
    v_mfma_f32_16x16x32_bf16 v[40:43], a[244:247], v[24:27], v[40:43]
    s_add_u32 m0, s56, 27648
    s_nop 0
    buffer_load_dwordx4 v5, s[8:11], s55 offen offset:2048 nt lds
    v_mfma_f32_16x16x32_bf16 v[40:43], v[236:239], v[28:31], v[40:43]
    v_mfma_f32_16x16x32_bf16 v[44:47], a[248:251], v[24:27], v[44:47]
    v_mfma_f32_16x16x32_bf16 v[44:47], v[240:243], v[28:31], v[44:47]
    v_mfma_f32_16x16x32_bf16 v[48:51], a[252:255], v[24:27], v[48:51]
    v_mfma_f32_16x16x32_bf16 v[48:51], v[244:247], v[28:31], v[48:51]
    v_mfma_f32_16x16x32_bf16 v[52:55], v[224:227], v[24:27], v[52:55]
    v_mfma_f32_16x16x32_bf16 v[52:55], v[248:251], v[28:31], v[52:55]
    v_mfma_f32_16x16x32_bf16 v[56:59], v[228:231], v[24:27], v[56:59]
    v_mfma_f32_16x16x32_bf16 v[56:59], v[252:255], v[28:31], v[56:59]
    s_waitcnt lgkmcnt(1)
    v_mfma_f32_16x16x32_bf16 v[60:63], a[0:3], v[16:19], v[84:87]
    ds_read_b128 v[24:27], v8 offset:25344
    s_waitcnt lgkmcnt(1)
    v_mfma_f32_16x16x32_bf16 v[60:63], a[24:27], v[20:23], v[60:63]
    ds_read_b128 v[28:31], v9 offset:25344
    v_mfma_f32_16x16x32_bf16 v[64:67], a[4:7], v[16:19], v[88:91]
    v_cvt_pk_bf16_f32 v52, v52, v53
    v_mfma_f32_16x16x32_bf16 v[64:67], a[28:31], v[20:23], v[64:67]
    v_mfma_f32_16x16x32_bf16 v[68:71], a[8:11], v[16:19], v[92:95]
    v_cvt_pk_bf16_f32 v53, v54, v55
    v_mfma_f32_16x16x32_bf16 v[68:71], a[32:35], v[20:23], v[68:71]
    v_mfma_f32_16x16x32_bf16 v[72:75], a[12:15], v[16:19], v[96:99]
    v_cvt_pk_bf16_f32 v54, v56, v57
    v_mfma_f32_16x16x32_bf16 v[72:75], a[36:39], v[20:23], v[72:75]
    v_mfma_f32_16x16x32_bf16 v[76:79], a[16:19], v[16:19], v[100:103]
    v_cvt_pk_bf16_f32 v55, v58, v59
    v_mfma_f32_16x16x32_bf16 v[76:79], a[40:43], v[20:23], v[76:79]
    v_mfma_f32_16x16x32_bf16 v[80:83], a[20:23], v[16:19], v[104:107]
    s_add_u32 s53, s53, 4
    s_cmp_ge_u32 s53, 12
    s_cselect_b32 s38, 294912, 0
    s_cselect_b32 s39, 12, 0
    v_mfma_f32_16x16x32_bf16 v[80:83], a[44:47], v[20:23], v[80:83]
    s_waitcnt lgkmcnt(1)
    v_mfma_f32_16x16x32_bf16 v[60:63], a[48:51], v[24:27], v[60:63]
    ds_read_b128 v[16:19], v6 offset:25600
    s_waitcnt lgkmcnt(1)
    v_mfma_f32_16x16x32_bf16 v[60:63], a[72:75], v[28:31], v[60:63]
    ds_read_b128 v[20:23], v7 offset:25600
    v_mfma_f32_16x16x32_bf16 v[64:67], a[52:55], v[24:27], v[64:67]
    ds_write_b128 v10, v[52:55] offset:8192
    v_cvt_pk_bf16_f32 v36, v36, v37
    v_mfma_f32_16x16x32_bf16 v[64:67], a[76:79], v[28:31], v[64:67]
    v_cvt_pk_bf16_f32 v37, v38, v39
    v_mfma_f32_16x16x32_bf16 v[68:71], a[56:59], v[24:27], v[68:71]
    v_cvt_pk_bf16_f32 v38, v40, v41
    v_cvt_pk_bf16_f32 v39, v42, v43
    v_mfma_f32_16x16x32_bf16 v[68:71], a[80:83], v[28:31], v[68:71]
    s_sub_u32 s53, s53, s39
    s_add_u32 s52, s52, s38
    s_add_u32 s52, s52, 12484608
    v_mfma_f32_16x16x32_bf16 v[72:75], a[60:63], v[24:27], v[72:75]
    v_cvt_pk_bf16_f32 v44, v44, v45
    v_cvt_pk_bf16_f32 v45, v46, v47
    v_mfma_f32_16x16x32_bf16 v[72:75], a[84:87], v[28:31], v[72:75]
    v_cvt_pk_bf16_f32 v46, v48, v49
    v_mfma_f32_16x16x32_bf16 v[76:79], a[64:67], v[24:27], v[76:79]
    v_cvt_pk_bf16_f32 v47, v50, v51
    v_mov_b32 v40, v36
    v_mfma_f32_16x16x32_bf16 v[76:79], a[88:91], v[28:31], v[76:79]
    v_mov_b32 v41, v37
    v_mfma_f32_16x16x32_bf16 v[80:83], a[68:71], v[24:27], v[80:83]
    v_mov_b32 v42, v38
    v_mov_b32 v43, v39
    v_mfma_f32_16x16x32_bf16 v[80:83], a[92:95], v[28:31], v[80:83]
    s_add_u32 s90, s90, 49152
    s_cmp_ge_u32 s90, s91
    s_cselect_b32 s38, 147456, 0
    s_sub_u32 s90, s90, s38
    s_waitcnt lgkmcnt(2)
    s_waitcnt vmcnt(12)
    s_waitcnt lgkmcnt(0)
    s_barrier
    v_mfma_f32_16x16x32_bf16 v[60:63], a[96:99], v[16:19], v[60:63]
    ds_read_b128 v[24:27], v8 offset:25600
    v_mfma_f32_16x16x32_bf16 v[60:63], a[120:123], v[20:23], v[60:63]
    ds_read_b128 v[28:31], v9 offset:25600
    v_mfma_f32_16x16x32_bf16 v[64:67], a[100:103], v[16:19], v[64:67]
    v_mov_b32_dpp v36, v44 row_ror:8 row_mask:0xf bank_mask:0xc
    v_mov_b32_dpp v37, v45 row_ror:8 row_mask:0xf bank_mask:0xc
    v_mfma_f32_16x16x32_bf16 v[64:67], a[124:127], v[20:23], v[64:67]
    v_mov_b32_dpp v38, v46 row_ror:8 row_mask:0xf bank_mask:0xc
    v_mfma_f32_16x16x32_bf16 v[68:71], a[104:107], v[16:19], v[68:71]
    v_mov_b32_dpp v39, v47 row_ror:8 row_mask:0xf bank_mask:0xc
    v_mfma_f32_16x16x32_bf16 v[68:71], a[128:131], v[20:23], v[68:71]
    ds_read_b128 v[48:51], v11 offset:4096
    ds_read_b128 v[56:59], v11 offset:8192
    v_mfma_f32_16x16x32_bf16 v[72:75], a[108:111], v[16:19], v[72:75]
    s_cmp_lt_u32 s60, 7
    s_cselect_b32 s94, s51, 0x80000000
    s_mov_b32 s95, s90
    v_mfma_f32_16x16x32_bf16 v[72:75], a[132:135], v[20:23], v[72:75]
    v_mov_b32_dpp v44, v40 row_ror:8 row_mask:0xf bank_mask:0x3
    v_mfma_f32_16x16x32_bf16 v[76:79], a[112:115], v[16:19], v[76:79]
    v_mov_b32_dpp v45, v41 row_ror:8 row_mask:0xf bank_mask:0x3
    v_mov_b32_dpp v46, v42 row_ror:8 row_mask:0xf bank_mask:0x3
    v_mfma_f32_16x16x32_bf16 v[76:79], a[136:139], v[20:23], v[76:79]
    v_mov_b32_dpp v47, v43 row_ror:8 row_mask:0xf bank_mask:0x3
    v_mfma_f32_16x16x32_bf16 v[80:83], a[116:119], v[16:19], v[80:83]
    buffer_store_dwordx4 v[36:39], v12, s[20:23], s49 offen offset:0 sc1
    v_mfma_f32_16x16x32_bf16 v[80:83], a[140:143], v[20:23], v[80:83]
    s_cmp_lt_u32 s60, 7
    s_cselect_b64 vcc, 0, -1
    s_mov_b32 s54, s94
    s_mov_b32 s56, s95
    s_add_u32 s55, s94, 294912
    s_waitcnt lgkmcnt(3)
    v_mfma_f32_16x16x32_bf16 v[60:63], a[144:147], v[24:27], v[60:63]
    ds_read_b128 v[16:19], v6 offset:25856
    s_waitcnt lgkmcnt(3)
    v_mfma_f32_16x16x32_bf16 v[60:63], a[168:171], v[28:31], v[60:63]
    ds_read_b128 v[20:23], v7 offset:25856
    v_mfma_f32_16x16x32_bf16 v[64:67], a[148:151], v[24:27], v[64:67]
    s_add_u32 m0, s56, 0
    s_nop 0
    buffer_load_dwordx4 v0, s[8:11], s54 offen offset:0 nt lds
    v_mfma_f32_16x16x32_bf16 v[64:67], a[172:175], v[28:31], v[64:67]
    v_mfma_f32_16x16x32_bf16 v[68:71], a[152:155], v[24:27], v[68:71]
    s_set_gpr_idx_on s59, gpr_idx(SRC1)
    v_lshlrev_b32 v84, 16, v108
    v_and_b32 v85, 0xffff0000, v108
    v_lshlrev_b32 v86, 16, v109
    v_and_b32 v87, 0xffff0000, v109
    s_set_gpr_idx_off
    v_mfma_f32_16x16x32_bf16 v[68:71], a[176:179], v[28:31], v[68:71]
    v_mfma_f32_16x16x32_bf16 v[72:75], a[156:159], v[24:27], v[72:75]
    v_mfma_f32_16x16x32_bf16 v[72:75], a[180:183], v[28:31], v[72:75]
    buffer_store_dwordx4 v[44:47], v13, s[20:23], s49 offen offset:0 sc1
    v_mfma_f32_16x16x32_bf16 v[76:79], a[160:163], v[24:27], v[76:79]
    v_mfma_f32_16x16x32_bf16 v[76:79], a[184:187], v[28:31], v[76:79]
    s_set_gpr_idx_on s59, gpr_idx(SRC1)
    v_lshlrev_b32 v88, 16, v110
    v_and_b32 v89, 0xffff0000, v110
    v_lshlrev_b32 v90, 16, v111
    v_and_b32 v91, 0xffff0000, v111
    s_set_gpr_idx_off
    v_mfma_f32_16x16x32_bf16 v[80:83], a[164:167], v[24:27], v[80:83]
    v_mfma_f32_16x16x32_bf16 v[80:83], a[188:191], v[28:31], v[80:83]
    s_waitcnt lgkmcnt(1)
    v_mfma_f32_16x16x32_bf16 v[60:63], a[192:195], v[16:19], v[60:63]
    ds_read_b128 v[24:27], v8 offset:25856
    s_waitcnt lgkmcnt(1)
    v_mfma_f32_16x16x32_bf16 v[60:63], a[216:219], v[20:23], v[60:63]
    ds_read_b128 v[28:31], v9 offset:25856
    v_mfma_f32_16x16x32_bf16 v[64:67], a[196:199], v[16:19], v[64:67]
    buffer_store_dwordx4 v[48:51], v14, s[20:23], s48 offen offset:768 sc1
    v_mfma_f32_16x16x32_bf16 v[64:67], a[220:223], v[20:23], v[64:67]
    v_add_u32 v6, s57, v6
    v_mfma_f32_16x16x32_bf16 v[68:71], a[200:203], v[16:19], v[68:71]
    v_add_u32 v7, s57, v7
    v_mfma_f32_16x16x32_bf16 v[68:71], a[224:227], v[20:23], v[68:71]
    v_add_u32 v8, s57, v8
    v_mfma_f32_16x16x32_bf16 v[72:75], a[204:207], v[16:19], v[72:75]
    v_mfma_f32_16x16x32_bf16 v[72:75], a[228:231], v[20:23], v[72:75]
    v_add_u32 v9, s57, v9
    v_mfma_f32_16x16x32_bf16 v[76:79], a[208:211], v[16:19], v[76:79]
    s_set_gpr_idx_on s59, gpr_idx(SRC1)
    v_lshlrev_b32 v92, 16, v112
    v_and_b32 v93, 0xffff0000, v112
    v_lshlrev_b32 v94, 16, v113
    v_and_b32 v95, 0xffff0000, v113
    s_set_gpr_idx_off
    v_mfma_f32_16x16x32_bf16 v[76:79], a[232:235], v[20:23], v[76:79]
    s_add_u32 m0, s56, 0
    s_nop 0
    buffer_load_dwordx4 v1, s[8:11], s54 offen offset:1024 nt lds
    v_mfma_f32_16x16x32_bf16 v[80:83], a[212:215], v[16:19], v[80:83]
    s_set_gpr_idx_on s59, gpr_idx(SRC1)
    v_lshlrev_b32 v96, 16, v114
    v_and_b32 v97, 0xffff0000, v114
    v_lshlrev_b32 v98, 16, v115
    v_and_b32 v99, 0xffff0000, v115
    s_set_gpr_idx_off
    v_mfma_f32_16x16x32_bf16 v[80:83], a[236:239], v[20:23], v[80:83]
    s_waitcnt lgkmcnt(1)
    v_mfma_f32_16x16x32_bf16 v[60:63], a[240:243], v[24:27], v[60:63]
    ds_read_b128 v[16:19], v6 offset:0
    s_waitcnt lgkmcnt(1)
    v_mfma_f32_16x16x32_bf16 v[60:63], v[232:235], v[28:31], v[60:63]
    ds_read_b128 v[20:23], v7 offset:0
    v_mfma_f32_16x16x32_bf16 v[64:67], a[244:247], v[24:27], v[64:67]
    buffer_store_dwordx4 v[56:59], v14, s[20:23], s49 offen offset:0 sc1
    v_mfma_f32_16x16x32_bf16 v[64:67], v[236:239], v[28:31], v[64:67]
    s_set_gpr_idx_on s59, gpr_idx(SRC1)
    v_lshlrev_b32 v100, 16, v116
    v_and_b32 v101, 0xffff0000, v116
    v_lshlrev_b32 v102, 16, v117
    v_and_b32 v103, 0xffff0000, v117
    s_set_gpr_idx_off
    v_mfma_f32_16x16x32_bf16 v[68:71], a[248:251], v[24:27], v[68:71]
    v_mfma_f32_16x16x32_bf16 v[68:71], v[240:243], v[28:31], v[68:71]
    s_add_u32 m0, s56, 0
    s_nop 0
    buffer_load_dwordx4 v2, s[8:11], s54 offen offset:2048 nt lds
    v_mfma_f32_16x16x32_bf16 v[72:75], a[252:255], v[24:27], v[72:75]
    v_mfma_f32_16x16x32_bf16 v[72:75], v[244:247], v[28:31], v[72:75]
    s_set_gpr_idx_on s59, gpr_idx(SRC1)
    v_lshlrev_b32 v104, 16, v118
    v_and_b32 v105, 0xffff0000, v118
    v_lshlrev_b32 v106, 16, v119
    v_and_b32 v107, 0xffff0000, v119
    s_set_gpr_idx_off
    v_mfma_f32_16x16x32_bf16 v[76:79], v[224:227], v[24:27], v[76:79]
    s_mov_b32 s47, s49
    s_mov_b32 s48, s50
    v_mfma_f32_16x16x32_bf16 v[76:79], v[248:251], v[28:31], v[76:79]
    v_mfma_f32_16x16x32_bf16 v[80:83], v[228:231], v[24:27], v[80:83]
    s_add_u32 s49, s50, 294912
    s_add_u32 s60, s60, 1
    v_mfma_f32_16x16x32_bf16 v[80:83], v[252:255], v[28:31], v[80:83]
    s_cmp_lt_u32 s60, 9
    s_cbranch_scc1 L_top
    s_nop 7
    v_cvt_pk_bf16_f32 v76, v76, v77
    v_cvt_pk_bf16_f32 v77, v78, v79
    v_cvt_pk_bf16_f32 v78, v80, v81
    v_cvt_pk_bf16_f32 v79, v82, v83
    ds_write_b128 v10, v[76:79] offset:12288
    v_cvt_pk_bf16_f32 v60, v60, v61
    v_cvt_pk_bf16_f32 v61, v62, v63
    v_cvt_pk_bf16_f32 v62, v64, v65
    v_cvt_pk_bf16_f32 v63, v66, v67
    v_cvt_pk_bf16_f32 v68, v68, v69
    v_cvt_pk_bf16_f32 v69, v70, v71
    v_cvt_pk_bf16_f32 v70, v72, v73
    v_cvt_pk_bf16_f32 v71, v74, v75
    v_mov_b32 v64, v60
    v_mov_b32 v65, v61
    v_mov_b32 v66, v62
    v_mov_b32 v67, v63
    v_mov_b32_dpp v60, v68 row_ror:8 row_mask:0xf bank_mask:0xc
    v_mov_b32_dpp v61, v69 row_ror:8 row_mask:0xf bank_mask:0xc
    v_mov_b32_dpp v62, v70 row_ror:8 row_mask:0xf bank_mask:0xc
    v_mov_b32_dpp v63, v71 row_ror:8 row_mask:0xf bank_mask:0xc
    v_mov_b32_dpp v68, v64 row_ror:8 row_mask:0xf bank_mask:0x3
    v_mov_b32_dpp v69, v65 row_ror:8 row_mask:0xf bank_mask:0x3
    v_mov_b32_dpp v70, v66 row_ror:8 row_mask:0xf bank_mask:0x3
    v_mov_b32_dpp v71, v67 row_ror:8 row_mask:0xf bank_mask:0x3
    s_waitcnt lgkmcnt(0)
    s_barrier
    ds_read_b128 v[80:83], v11 offset:12288
    buffer_store_dwordx4 v[60:63], v12, s[20:23], s47 offen offset:768 sc1
    buffer_store_dwordx4 v[68:71], v13, s[20:23], s47 offen offset:768 sc1
    s_waitcnt lgkmcnt(0)
    buffer_store_dwordx4 v[80:83], v14, s[20:23], s47 offen offset:768 sc1
L_end:
    s_endpgm
.fill 4096, 4, 0xBF800000
.section .rodata,"a"
.p2align 6
.amdhsa_kernel standalone__detection_seg_fpn_lateral__vision_kernel
  .amdhsa_next_free_vgpr 512
  .amdhsa_next_free_sgpr 96
  .amdhsa_accum_offset 256
  .amdhsa_group_segment_fixed_size 0
  .amdhsa_kernarg_size 56
  .amdhsa_user_sgpr_count 2
  .amdhsa_user_sgpr_kernarg_segment_ptr 1
  .amdhsa_system_sgpr_workgroup_id_x 1
.end_amdhsa_kernel
```
